```python
import torch

def _softmax(x, axis=-1):
    return torch.softmax(x, dim=axis)
def _gelu(x):
    return torch.nn.functional.gelu(x, approximate="tanh")
def _silu(x):
    return torch.nn.functional.silu(x)
def _sigmoid(x):
    return torch.sigmoid(x)
def _layernorm(x, axis=-1, eps=1e-5):
    m = x.mean(dim=axis, keepdim=True)
    v = x.var(dim=axis, keepdim=True, unbiased=False)
    return (x - m) / torch.sqrt(v + eps)
def _scatter_add(tgt, idx, src, axis=0):
    return tgt.clone().index_add_(axis, idx, src)
def _segment_sum(src, seg, n):
    out = torch.zeros((n,) + src.shape[1:], dtype=src.dtype)
    return out.index_add_(0, seg, src)
def _pad(x, pw):
    flat = tuple(v for pair in reversed(pw) for v in pair)
    return torch.nn.functional.pad(x, flat)

kernel_name = 'concat_heads__mha_block_cached__compressed_kv_cla__decode'

def setup_inputs():

    _w = (lambda a: (lambda t: t.to(torch.bfloat16) if t.is_floating_point() else t)(torch.as_tensor(a)))
    def _A_setup():
        B, Sq, D = 1, 1, 640
        H, Sk, Dh = 32, 8192, 192
        return {
            "x": _w((lambda *s: torch.randn(*s, dtype=torch.bfloat16) * 1.6)(B, Sq, D)),
            "k_cache": _w((lambda *s: torch.randn(*s, dtype=torch.bfloat16) * 1.6)(B, H, Sk, Dh)),
            "v_cache": _w((lambda *s: torch.randn(*s, dtype=torch.bfloat16) * 0.05)(B, H, Sk, Dh)),
            "wq": _w((lambda *s: torch.randn(*s, dtype=torch.bfloat16) * 1.6)(D, H * Dh) * (D ** -0.5)),
            "wo": _w((lambda *s: torch.randn(*s, dtype=torch.bfloat16) * 0.05)(H * Dh, D) * ((H * Dh) ** -0.5)),
        }
    _A_in = _A_setup()

    def _B_setup():
        B, H, Sq, Sk, D, M = 1, 32, 1, 8192, 192, 640
        Dc = 4 * D
        return {
            "x": _w((lambda *s: torch.randn(*s, dtype=torch.bfloat16) * 3.2)(B, Sq, M)),
            "c_kv": _w((lambda *s: torch.randn(*s, dtype=torch.bfloat16) * 0.1)(B, Sk, Dc)),
            "w_q": _w((lambda *s: torch.randn(*s, dtype=torch.bfloat16) * 6.4)(M, H, D) * (M ** -0.5)),
            "w_uk": _w((lambda *s: torch.randn(*s, dtype=torch.bfloat16) * 6.4)(Dc, H, D) * (Dc ** -0.5)),
            "w_uv": _w((lambda *s: torch.randn(*s, dtype=torch.bfloat16) * 0.1)(Dc, H, D) * (Dc ** -0.5)),
            "w_o": _w((lambda *s: torch.randn(*s, dtype=torch.bfloat16) * 0.1)(H, D, M) * ((H * D) ** -0.5)),
        }
    _B_in = _B_setup()

    return {
        "A_x": _A_in["x"],
        "A_k_cache": _A_in["k_cache"],
        "A_v_cache": _A_in["v_cache"],
        "A_wq": _A_in["wq"],
        "A_wo": _A_in["wo"],
        "B_x": _B_in["x"],
        "B_c_kv": _B_in["c_kv"],
        "B_w_q": _B_in["w_q"],
        "B_w_uk": _B_in["w_uk"],
        "B_w_uv": _B_in["w_uv"],
        "B_w_o": _B_in["w_o"],
    }

def reference(A_x, A_k_cache, A_v_cache, A_wq, A_wo, B_x, B_c_kv, B_w_q, B_w_uk, B_w_uv, B_w_o):
    def _A_ref(x, k_cache, v_cache, wq, wo):
        B, Sq, D = x.shape
        H, Dh = 32, 192
        q = (lambda x, *d: x.permute(*d))((x @ wq).reshape(B, Sq, H, Dh), 0, 2, 1, 3)
        scores = torch.einsum("bhqd,bhkd->bhqk", q, k_cache) * (Dh ** -0.5)
        p = _softmax(scores, axis=-1)
        o = torch.einsum("bhqk,bhkd->bhqd", p, v_cache)
        return (lambda x, *d: x.permute(*d))(o, 0, 2, 1, 3).reshape(B, Sq, H * Dh) @ wo

    def _B_ref(x, c_kv, w_q, w_uk, w_uv, w_o):
        B, Sq, M = x.shape[0], x.shape[1], x.shape[2]
        Sk = c_kv.shape[1]
        H, D = w_q.shape[1], w_q.shape[2]
        q = torch.einsum("bqm,mhd->bhqd", x, w_q)
        k = torch.einsum("bkc,chd->bhkd", c_kv, w_uk)
        v = torch.einsum("bkc,chd->bhkd", c_kv, w_uv)
        scores = torch.einsum("bhqd,bhkd->bhqk", q, k) * (D ** -0.5)
        off = Sk - Sq
        qi = torch.arange(Sq)[:, None]
        kj = torch.arange(Sk)[None, :]
        cmask = kj <= (qi + off)
        scores = torch.where(cmask[None, None], scores, -1e9)
        p = _softmax(scores, axis=-1)
        ctx = torch.einsum("bhqk,bhkd->bhqd", p, v)
        return torch.einsum("bhqd,hdm->bqm", ctx, w_o)

    a = _A_ref(A_x, A_k_cache, A_v_cache, A_wq, A_wo)
    b = _B_ref(B_x, B_c_kv, B_w_q, B_w_uk, B_w_uv, B_w_o)
    return torch.concatenate([a, b], axis=-1)
```

```asm
; @launch kernel=prep_kernel grid=(512,1,1) block=(256,1,1) lds=16384
; @launch kernel=attn_kernel grid=(384,1,1) block=(256,1,1) lds=53760
; @launch kernel=comb_kernel grid=(384,1,1) block=(256,1,1) lds=16384
; @launch kernel=projb_kernel grid=(128,1,1) block=(256,1,1) lds=16384
; @launch kernel=fin_kernel grid=(20,1,1) block=(256,1,1) lds=1024
.amdgcn_target "amdgcn-amd-amdhsa--gfx950"
.text
.globl prep_kernel
.globl attn_kernel
.globl comb_kernel
.globl projb_kernel
.globl fin_kernel
.p2align 8
.type prep_kernel,@function
prep_kernel:
    s_cmp_ge_u32 s2, 512
    s_cbranch_scc1 prep_exit
    s_load_dwordx2 s[4:5], s[0:1], 104
    v_lshrrev_b32 v1, 6, v0
    s_nop 0
    v_readfirstlane_b32 s3, v1
    v_and_b32 v2, 63, v0
    v_lshrrev_b32 v3, 5, v2
    v_and_b32 v4, 31, v2
    v_mul_u32_u24 v5, 12, v4
    v_lshlrev_b32 v6, 4, v3
    s_and_b32 s6, s2, 31
    s_cmp_lt_u32 s2, 256
    s_cbranch_scc1 prep_B

    s_load_dwordx2 s[12:13], s[0:1], 0
    s_load_dwordx2 s[14:15], s[0:1], 24
    s_sub_u32 s7, s2, 256
    s_lshr_b32 s7, s7, 5
    s_waitcnt lgkmcnt(0)

    s_mov_b32 s8, s14
    s_and_b32 s9, s15, 0xffff
    s_mov_b32 s10, 7864320
    s_mov_b32 s11, 0x00020000

    s_mul_i32 s16, s7, 80
    s_mul_i32 s17, s3, 20
    s_add_u32 s16, s16, s17
    s_lshl_b32 s17, s16, 1
    s_add_u32 s12, s12, s17
    s_addc_u32 s13, s13, 0
    s_load_dwordx8 s[24:31], s[12:13], 0
    s_load_dwordx2 s[32:33], s[12:13], 32
    s_mul_i32 s18, s16, 12288
    s_mul_i32 s19, s6, 384
    s_add_u32 s18, s18, s19
    v_mul_u32_u24 v7, 12288, v3
    v_add_u32 v7, v7, v5

    v_mov_b32 v10, 0
    v_mov_b32 v11, 0
    v_mov_b32 v12, 0
    v_mov_b32 v13, 0
    v_mov_b32 v14, 0
    v_mov_b32 v15, 0
    buffer_load_dwordx3 v[20:22], v7, s[8:11], s18 offen
    s_add_u32 s18, s18, 24576
    buffer_load_dwordx3 v[24:26], v7, s[8:11], s18 offen
    s_add_u32 s18, s18, 24576
    buffer_load_dwordx3 v[28:30], v7, s[8:11], s18 offen
    s_add_u32 s18, s18, 24576
    buffer_load_dwordx3 v[32:34], v7, s[8:11], s18 offen
    s_add_u32 s18, s18, 24576
    buffer_load_dwordx3 v[36:38], v7, s[8:11], s18 offen
    s_add_u32 s18, s18, 24576
    buffer_load_dwordx3 v[40:42], v7, s[8:11], s18 offen
    s_add_u32 s18, s18, 24576
    buffer_load_dwordx3 v[44:46], v7, s[8:11], s18 offen
    s_add_u32 s18, s18, 24576
    buffer_load_dwordx3 v[48:50], v7, s[8:11], s18 offen
    s_add_u32 s18, s18, 24576
    buffer_load_dwordx3 v[52:54], v7, s[8:11], s18 offen
    s_add_u32 s18, s18, 24576
    buffer_load_dwordx3 v[56:58], v7, s[8:11], s18 offen
    s_waitcnt lgkmcnt(0)
    s_waitcnt vmcnt(9)
    v_lshrrev_b32 v8, v6, s24
    v_and_b32 v8, 0xffff, v8
    v_lshlrev_b32 v9, 16, v8

    v_dot2_f32_bf16 v10, v20, v8, v10
    v_dot2_f32_bf16 v11, v20, v9, v11
    v_dot2_f32_bf16 v12, v21, v8, v12
    v_dot2_f32_bf16 v13, v21, v9, v13
    v_dot2_f32_bf16 v14, v22, v8, v14
    v_dot2_f32_bf16 v15, v22, v9, v15
    s_waitcnt vmcnt(8)
    v_lshrrev_b32 v8, v6, s25
    v_and_b32 v8, 0xffff, v8
    v_lshlrev_b32 v9, 16, v8

    v_dot2_f32_bf16 v10, v24, v8, v10
    v_dot2_f32_bf16 v11, v24, v9, v11
    v_dot2_f32_bf16 v12, v25, v8, v12
    v_dot2_f32_bf16 v13, v25, v9, v13
    v_dot2_f32_bf16 v14, v26, v8, v14
    v_dot2_f32_bf16 v15, v26, v9, v15
    s_waitcnt vmcnt(7)
    v_lshrrev_b32 v8, v6, s26
    v_and_b32 v8, 0xffff, v8
    v_lshlrev_b32 v9, 16, v8

    v_dot2_f32_bf16 v10, v28, v8, v10
    v_dot2_f32_bf16 v11, v28, v9, v11
    v_dot2_f32_bf16 v12, v29, v8, v12
    v_dot2_f32_bf16 v13, v29, v9, v13
    v_dot2_f32_bf16 v14, v30, v8, v14
    v_dot2_f32_bf16 v15, v30, v9, v15
    s_waitcnt vmcnt(6)
    v_lshrrev_b32 v8, v6, s27
    v_and_b32 v8, 0xffff, v8
    v_lshlrev_b32 v9, 16, v8

    v_dot2_f32_bf16 v10, v32, v8, v10
    v_dot2_f32_bf16 v11, v32, v9, v11
    v_dot2_f32_bf16 v12, v33, v8, v12
    v_dot2_f32_bf16 v13, v33, v9, v13
    v_dot2_f32_bf16 v14, v34, v8, v14
    v_dot2_f32_bf16 v15, v34, v9, v15
    s_waitcnt vmcnt(5)
    v_lshrrev_b32 v8, v6, s28
    v_and_b32 v8, 0xffff, v8
    v_lshlrev_b32 v9, 16, v8

    v_dot2_f32_bf16 v10, v36, v8, v10
    v_dot2_f32_bf16 v11, v36, v9, v11
    v_dot2_f32_bf16 v12, v37, v8, v12
    v_dot2_f32_bf16 v13, v37, v9, v13
    v_dot2_f32_bf16 v14, v38, v8, v14
    v_dot2_f32_bf16 v15, v38, v9, v15
    s_waitcnt vmcnt(4)
    v_lshrrev_b32 v8, v6, s29
    v_and_b32 v8, 0xffff, v8
    v_lshlrev_b32 v9, 16, v8

    v_dot2_f32_bf16 v10, v40, v8, v10
    v_dot2_f32_bf16 v11, v40, v9, v11
    v_dot2_f32_bf16 v12, v41, v8, v12
    v_dot2_f32_bf16 v13, v41, v9, v13
    v_dot2_f32_bf16 v14, v42, v8, v14
    v_dot2_f32_bf16 v15, v42, v9, v15
    s_waitcnt vmcnt(3)
    v_lshrrev_b32 v8, v6, s30
    v_and_b32 v8, 0xffff, v8
    v_lshlrev_b32 v9, 16, v8

    v_dot2_f32_bf16 v10, v44, v8, v10
    v_dot2_f32_bf16 v11, v44, v9, v11
    v_dot2_f32_bf16 v12, v45, v8, v12
    v_dot2_f32_bf16 v13, v45, v9, v13
    v_dot2_f32_bf16 v14, v46, v8, v14
    v_dot2_f32_bf16 v15, v46, v9, v15
    s_waitcnt vmcnt(2)
    v_lshrrev_b32 v8, v6, s31
    v_and_b32 v8, 0xffff, v8
    v_lshlrev_b32 v9, 16, v8

    v_dot2_f32_bf16 v10, v48, v8, v10
    v_dot2_f32_bf16 v11, v48, v9, v11
    v_dot2_f32_bf16 v12, v49, v8, v12
    v_dot2_f32_bf16 v13, v49, v9, v13
    v_dot2_f32_bf16 v14, v50, v8, v14
    v_dot2_f32_bf16 v15, v50, v9, v15
    s_waitcnt vmcnt(1)
    v_lshrrev_b32 v8, v6, s32
    v_and_b32 v8, 0xffff, v8
    v_lshlrev_b32 v9, 16, v8

    v_dot2_f32_bf16 v10, v52, v8, v10
    v_dot2_f32_bf16 v11, v52, v9, v11
    v_dot2_f32_bf16 v12, v53, v8, v12
    v_dot2_f32_bf16 v13, v53, v9, v13
    v_dot2_f32_bf16 v14, v54, v8, v14
    v_dot2_f32_bf16 v15, v54, v9, v15
    s_waitcnt vmcnt(0)
    v_lshrrev_b32 v8, v6, s33
    v_and_b32 v8, 0xffff, v8
    v_lshlrev_b32 v9, 16, v8

    v_dot2_f32_bf16 v10, v56, v8, v10
    v_dot2_f32_bf16 v11, v56, v9, v11
    v_dot2_f32_bf16 v12, v57, v8, v12
    v_dot2_f32_bf16 v13, v57, v9, v13
    v_dot2_f32_bf16 v14, v58, v8, v14
    v_dot2_f32_bf16 v15, v58, v9, v15
    v_lshlrev_b32 v16, 1, v1
    v_add_u32 v16, v16, v3
    v_mul_u32_u24 v16, 768, v16
    v_lshlrev_b32 v17, 1, v5
    v_add_u32 v16, v16, v17
    ds_write_b64 v16, v[10:11]
    ds_write_b64 v16, v[12:13] offset:8
    ds_write_b64 v16, v[14:15] offset:16
    s_waitcnt lgkmcnt(0)
    s_barrier
    v_cmp_gt_u32 vcc, 192, v0
    s_and_saveexec_b64 s[20:21], vcc
    s_cbranch_execz prep_exit
    v_lshlrev_b32 v16, 2, v0
    ds_read_b32 v20, v16
    ds_read_b32 v21, v16 offset:768
    ds_read_b32 v22, v16 offset:1536
    ds_read_b32 v23, v16 offset:2304
    ds_read_b32 v24, v16 offset:3072
    ds_read_b32 v25, v16 offset:3840
    ds_read_b32 v26, v16 offset:4608
    ds_read_b32 v27, v16 offset:5376
    s_waitcnt lgkmcnt(0)
    v_add_f32 v20, v20, v21
    v_add_f32 v22, v22, v23
    v_add_f32 v24, v24, v25
    v_add_f32 v26, v26, v27
    v_add_f32 v20, v20, v22
    v_add_f32 v24, v24, v26
    v_add_f32 v20, v20, v24

    s_mov_b32 s8, s4
    s_and_b32 s9, s5, 0xffff
    s_mov_b32 s10, 8388608
    s_mov_b32 s11, 0x00020000

    s_mul_i32 s16, s7, 24576
    s_mul_i32 s17, s6, 768
    s_add_u32 s16, s16, s17
    s_add_u32 s16, s16, 0
    buffer_store_dword v20, v16, s[8:11], s16 offen
    s_branch prep_exit

prep_B:
    s_load_dwordx2 s[12:13], s[0:1], 40
    s_load_dwordx2 s[14:15], s[0:1], 56
    s_lshr_b32 s7, s2, 5
    s_waitcnt lgkmcnt(0)

    s_mov_b32 s8, s14
    s_and_b32 s9, s15, 0xffff
    s_mov_b32 s10, 7864320
    s_mov_b32 s11, 0x00020000

    s_mul_i32 s16, s3, 160
    s_lshl_b32 s17, s16, 1
    s_add_u32 s12, s12, s17
    s_addc_u32 s13, s13, 0
    s_load_dwordx16 s[16+4:31+4], s[12:13], 0
    s_load_dwordx16 s[32+4:47+4], s[12:13], 64
    s_load_dwordx16 s[48+4:63+4], s[12:13], 128
    s_load_dwordx16 s[64+4:79+4], s[12:13], 192
    s_load_dwordx16 s[80+4:95+4], s[12:13], 256
    s_load_dwordx2 s[14:15], s[0:1], 64
    s_mul_i32 s18, s16, 12288
    s_mul_i32 s19, s6, 384
    s_add_u32 s18, s18, s19
    v_mul_u32_u24 v7, 12288, v3
    v_add_u32 v7, v7, v5

    v_mov_b32 v10, 0
    v_mov_b32 v11, 0
    v_mov_b32 v12, 0
    v_mov_b32 v13, 0
    v_mov_b32 v14, 0
    v_mov_b32 v15, 0
    buffer_load_dwordx3 v[20:22], v7, s[8:11], s18 offen
    s_add_u32 s18, s18, 24576
    buffer_load_dwordx3 v[24:26], v7, s[8:11], s18 offen
    s_add_u32 s18, s18, 24576
    buffer_load_dwordx3 v[28:30], v7, s[8:11], s18 offen
    s_add_u32 s18, s18, 24576
    buffer_load_dwordx3 v[32:34], v7, s[8:11], s18 offen
    s_add_u32 s18, s18, 24576
    buffer_load_dwordx3 v[36:38], v7, s[8:11], s18 offen
    s_add_u32 s18, s18, 24576
    buffer_load_dwordx3 v[40:42], v7, s[8:11], s18 offen
    s_add_u32 s18, s18, 24576
    buffer_load_dwordx3 v[44:46], v7, s[8:11], s18 offen
    s_add_u32 s18, s18, 24576
    buffer_load_dwordx3 v[48:50], v7, s[8:11], s18 offen
    s_add_u32 s18, s18, 24576
    buffer_load_dwordx3 v[52:54], v7, s[8:11], s18 offen
    s_add_u32 s18, s18, 24576
    buffer_load_dwordx3 v[56:58], v7, s[8:11], s18 offen
    s_add_u32 s18, s18, 24576
    buffer_load_dwordx3 v[60:62], v7, s[8:11], s18 offen
    s_add_u32 s18, s18, 24576
    buffer_load_dwordx3 v[64:66], v7, s[8:11], s18 offen
    s_add_u32 s18, s18, 24576
    buffer_load_dwordx3 v[68:70], v7, s[8:11], s18 offen
    s_add_u32 s18, s18, 24576
    buffer_load_dwordx3 v[72:74], v7, s[8:11], s18 offen
    s_add_u32 s18, s18, 24576
    buffer_load_dwordx3 v[76:78], v7, s[8:11], s18 offen
    s_add_u32 s18, s18, 24576
    buffer_load_dwordx3 v[80:82], v7, s[8:11], s18 offen
    s_add_u32 s18, s18, 24576
    buffer_load_dwordx3 v[84:86], v7, s[8:11], s18 offen
    s_add_u32 s18, s18, 24576
    buffer_load_dwordx3 v[88:90], v7, s[8:11], s18 offen
    s_add_u32 s18, s18, 24576
    buffer_load_dwordx3 v[92:94], v7, s[8:11], s18 offen
    s_add_u32 s18, s18, 24576
    buffer_load_dwordx3 v[96:98], v7, s[8:11], s18 offen
    s_add_u32 s18, s18, 24576
    buffer_load_dwordx3 v[100:102], v7, s[8:11], s18 offen
    s_add_u32 s18, s18, 24576
    buffer_load_dwordx3 v[104:106], v7, s[8:11], s18 offen
    s_add_u32 s18, s18, 24576
    buffer_load_dwordx3 v[108:110], v7, s[8:11], s18 offen
    s_add_u32 s18, s18, 24576
    buffer_load_dwordx3 v[112:114], v7, s[8:11], s18 offen
    s_add_u32 s18, s18, 24576
    buffer_load_dwordx3 v[116:118], v7, s[8:11], s18 offen
    s_add_u32 s18, s18, 24576
    buffer_load_dwordx3 v[120:122], v7, s[8:11], s18 offen
    s_add_u32 s18, s18, 24576
    buffer_load_dwordx3 v[124:126], v7, s[8:11], s18 offen
    s_add_u32 s18, s18, 24576
    buffer_load_dwordx3 v[128:130], v7, s[8:11], s18 offen
    s_add_u32 s18, s18, 24576
    buffer_load_dwordx3 v[132:134], v7, s[8:11], s18 offen
    s_add_u32 s18, s18, 24576
    buffer_load_dwordx3 v[136:138], v7, s[8:11], s18 offen
    s_add_u32 s18, s18, 24576
    buffer_load_dwordx3 v[140:142], v7, s[8:11], s18 offen
    s_add_u32 s18, s18, 24576
    buffer_load_dwordx3 v[144:146], v7, s[8:11], s18 offen
    s_add_u32 s18, s18, 24576
    buffer_load_dwordx3 v[148:150], v7, s[8:11], s18 offen
    s_add_u32 s18, s18, 24576
    buffer_load_dwordx3 v[152:154], v7, s[8:11], s18 offen
    s_add_u32 s18, s18, 24576
    buffer_load_dwordx3 v[156:158], v7, s[8:11], s18 offen
    s_add_u32 s18, s18, 24576
    buffer_load_dwordx3 v[160:162], v7, s[8:11], s18 offen
    s_add_u32 s18, s18, 24576
    buffer_load_dwordx3 v[164:166], v7, s[8:11], s18 offen
    s_add_u32 s18, s18, 24576
    buffer_load_dwordx3 v[168:170], v7, s[8:11], s18 offen
    s_add_u32 s18, s18, 24576
    buffer_load_dwordx3 v[172:174], v7, s[8:11], s18 offen
    s_add_u32 s18, s18, 24576
    buffer_load_dwordx3 v[176:178], v7, s[8:11], s18 offen
    s_add_u32 s18, s18, 24576
    s_waitcnt lgkmcnt(0)
    s_waitcnt vmcnt(39)
    v_lshrrev_b32 v8, v6, s20
    v_and_b32 v8, 0xffff, v8
    v_lshlrev_b32 v9, 16, v8

    v_dot2_f32_bf16 v10, v20, v8, v10
    v_dot2_f32_bf16 v11, v20, v9, v11
    v_dot2_f32_bf16 v12, v21, v8, v12
    v_dot2_f32_bf16 v13, v21, v9, v13
    v_dot2_f32_bf16 v14, v22, v8, v14
    v_dot2_f32_bf16 v15, v22, v9, v15
    buffer_load_dwordx3 v[20:22], v7, s[8:11], s18 offen
    s_add_u32 s18, s18, 24576
    s_waitcnt vmcnt(39)
    v_lshrrev_b32 v8, v6, s21
    v_and_b32 v8, 0xffff, v8
    v_lshlrev_b32 v9, 16, v8

    v_dot2_f32_bf16 v10, v24, v8, v10
    v_dot2_f32_bf16 v11, v24, v9, v11
    v_dot2_f32_bf16 v12, v25, v8, v12
    v_dot2_f32_bf16 v13, v25, v9, v13
    v_dot2_f32_bf16 v14, v26, v8, v14
    v_dot2_f32_bf16 v15, v26, v9, v15
    buffer_load_dwordx3 v[24:26], v7, s[8:11], s18 offen
    s_add_u32 s18, s18, 24576
    s_waitcnt vmcnt(39)
    v_lshrrev_b32 v8, v6, s22
    v_and_b32 v8, 0xffff, v8
    v_lshlrev_b32 v9, 16, v8

    v_dot2_f32_bf16 v10, v28, v8, v10
    v_dot2_f32_bf16 v11, v28, v9, v11
    v_dot2_f32_bf16 v12, v29, v8, v12
    v_dot2_f32_bf16 v13, v29, v9, v13
    v_dot2_f32_bf16 v14, v30, v8, v14
    v_dot2_f32_bf16 v15, v30, v9, v15
    buffer_load_dwordx3 v[28:30], v7, s[8:11], s18 offen
    s_add_u32 s18, s18, 24576
    s_waitcnt vmcnt(39)
    v_lshrrev_b32 v8, v6, s23
    v_and_b32 v8, 0xffff, v8
    v_lshlrev_b32 v9, 16, v8

    v_dot2_f32_bf16 v10, v32, v8, v10
    v_dot2_f32_bf16 v11, v32, v9, v11
    v_dot2_f32_bf16 v12, v33, v8, v12
    v_dot2_f32_bf16 v13, v33, v9, v13
    v_dot2_f32_bf16 v14, v34, v8, v14
    v_dot2_f32_bf16 v15, v34, v9, v15
    buffer_load_dwordx3 v[32:34], v7, s[8:11], s18 offen
    s_add_u32 s18, s18, 24576
    s_waitcnt vmcnt(39)
    v_lshrrev_b32 v8, v6, s24
    v_and_b32 v8, 0xffff, v8
    v_lshlrev_b32 v9, 16, v8

    v_dot2_f32_bf16 v10, v36, v8, v10
    v_dot2_f32_bf16 v11, v36, v9, v11
    v_dot2_f32_bf16 v12, v37, v8, v12
    v_dot2_f32_bf16 v13, v37, v9, v13
    v_dot2_f32_bf16 v14, v38, v8, v14
    v_dot2_f32_bf16 v15, v38, v9, v15
    buffer_load_dwordx3 v[36:38], v7, s[8:11], s18 offen
    s_add_u32 s18, s18, 24576
    s_waitcnt vmcnt(39)
    v_lshrrev_b32 v8, v6, s25
    v_and_b32 v8, 0xffff, v8
    v_lshlrev_b32 v9, 16, v8

    v_dot2_f32_bf16 v10, v40, v8, v10
    v_dot2_f32_bf16 v11, v40, v9, v11
    v_dot2_f32_bf16 v12, v41, v8, v12
    v_dot2_f32_bf16 v13, v41, v9, v13
    v_dot2_f32_bf16 v14, v42, v8, v14
    v_dot2_f32_bf16 v15, v42, v9, v15
    buffer_load_dwordx3 v[40:42], v7, s[8:11], s18 offen
    s_add_u32 s18, s18, 24576
    s_waitcnt vmcnt(39)
    v_lshrrev_b32 v8, v6, s26
    v_and_b32 v8, 0xffff, v8
    v_lshlrev_b32 v9, 16, v8

    v_dot2_f32_bf16 v10, v44, v8, v10
    v_dot2_f32_bf16 v11, v44, v9, v11
    v_dot2_f32_bf16 v12, v45, v8, v12
    v_dot2_f32_bf16 v13, v45, v9, v13
    v_dot2_f32_bf16 v14, v46, v8, v14
    v_dot2_f32_bf16 v15, v46, v9, v15
    buffer_load_dwordx3 v[44:46], v7, s[8:11], s18 offen
    s_add_u32 s18, s18, 24576
    s_waitcnt vmcnt(39)
    v_lshrrev_b32 v8, v6, s27
    v_and_b32 v8, 0xffff, v8
    v_lshlrev_b32 v9, 16, v8

    v_dot2_f32_bf16 v10, v48, v8, v10
    v_dot2_f32_bf16 v11, v48, v9, v11
    v_dot2_f32_bf16 v12, v49, v8, v12
    v_dot2_f32_bf16 v13, v49, v9, v13
    v_dot2_f32_bf16 v14, v50, v8, v14
    v_dot2_f32_bf16 v15, v50, v9, v15
    buffer_load_dwordx3 v[48:50], v7, s[8:11], s18 offen
    s_add_u32 s18, s18, 24576
    s_waitcnt vmcnt(39)
    v_lshrrev_b32 v8, v6, s28
    v_and_b32 v8, 0xffff, v8
    v_lshlrev_b32 v9, 16, v8

    v_dot2_f32_bf16 v10, v52, v8, v10
    v_dot2_f32_bf16 v11, v52, v9, v11
    v_dot2_f32_bf16 v12, v53, v8, v12
    v_dot2_f32_bf16 v13, v53, v9, v13
    v_dot2_f32_bf16 v14, v54, v8, v14
    v_dot2_f32_bf16 v15, v54, v9, v15
    buffer_load_dwordx3 v[52:54], v7, s[8:11], s18 offen
    s_add_u32 s18, s18, 24576
    s_waitcnt vmcnt(39)
    v_lshrrev_b32 v8, v6, s29
    v_and_b32 v8, 0xffff, v8
    v_lshlrev_b32 v9, 16, v8

    v_dot2_f32_bf16 v10, v56, v8, v10
    v_dot2_f32_bf16 v11, v56, v9, v11
    v_dot2_f32_bf16 v12, v57, v8, v12
    v_dot2_f32_bf16 v13, v57, v9, v13
    v_dot2_f32_bf16 v14, v58, v8, v14
    v_dot2_f32_bf16 v15, v58, v9, v15
    buffer_load_dwordx3 v[56:58], v7, s[8:11], s18 offen
    s_add_u32 s18, s18, 24576
    s_waitcnt vmcnt(39)
    v_lshrrev_b32 v8, v6, s30
    v_and_b32 v8, 0xffff, v8
    v_lshlrev_b32 v9, 16, v8

    v_dot2_f32_bf16 v10, v60, v8, v10
    v_dot2_f32_bf16 v11, v60, v9, v11
    v_dot2_f32_bf16 v12, v61, v8, v12
    v_dot2_f32_bf16 v13, v61, v9, v13
    v_dot2_f32_bf16 v14, v62, v8, v14
    v_dot2_f32_bf16 v15, v62, v9, v15
    buffer_load_dwordx3 v[60:62], v7, s[8:11], s18 offen
    s_add_u32 s18, s18, 24576
    s_waitcnt vmcnt(39)
    v_lshrrev_b32 v8, v6, s31
    v_and_b32 v8, 0xffff, v8
    v_lshlrev_b32 v9, 16, v8

    v_dot2_f32_bf16 v10, v64, v8, v10
    v_dot2_f32_bf16 v11, v64, v9, v11
    v_dot2_f32_bf16 v12, v65, v8, v12
    v_dot2_f32_bf16 v13, v65, v9, v13
    v_dot2_f32_bf16 v14, v66, v8, v14
    v_dot2_f32_bf16 v15, v66, v9, v15
    buffer_load_dwordx3 v[64:66], v7, s[8:11], s18 offen
    s_add_u32 s18, s18, 24576
    s_waitcnt vmcnt(39)
    v_lshrrev_b32 v8, v6, s32
    v_and_b32 v8, 0xffff, v8
    v_lshlrev_b32 v9, 16, v8

    v_dot2_f32_bf16 v10, v68, v8, v10
    v_dot2_f32_bf16 v11, v68, v9, v11
    v_dot2_f32_bf16 v12, v69, v8, v12
    v_dot2_f32_bf16 v13, v69, v9, v13
    v_dot2_f32_bf16 v14, v70, v8, v14
    v_dot2_f32_bf16 v15, v70, v9, v15
    buffer_load_dwordx3 v[68:70], v7, s[8:11], s18 offen
    s_add_u32 s18, s18, 24576
    s_waitcnt vmcnt(39)
    v_lshrrev_b32 v8, v6, s33
    v_and_b32 v8, 0xffff, v8
    v_lshlrev_b32 v9, 16, v8

    v_dot2_f32_bf16 v10, v72, v8, v10
    v_dot2_f32_bf16 v11, v72, v9, v11
    v_dot2_f32_bf16 v12, v73, v8, v12
    v_dot2_f32_bf16 v13, v73, v9, v13
    v_dot2_f32_bf16 v14, v74, v8, v14
    v_dot2_f32_bf16 v15, v74, v9, v15
    buffer_load_dwordx3 v[72:74], v7, s[8:11], s18 offen
    s_add_u32 s18, s18, 24576
    s_waitcnt vmcnt(39)
    v_lshrrev_b32 v8, v6, s34
    v_and_b32 v8, 0xffff, v8
    v_lshlrev_b32 v9, 16, v8

    v_dot2_f32_bf16 v10, v76, v8, v10
    v_dot2_f32_bf16 v11, v76, v9, v11
    v_dot2_f32_bf16 v12, v77, v8, v12
    v_dot2_f32_bf16 v13, v77, v9, v13
    v_dot2_f32_bf16 v14, v78, v8, v14
    v_dot2_f32_bf16 v15, v78, v9, v15
    buffer_load_dwordx3 v[76:78], v7, s[8:11], s18 offen
    s_add_u32 s18, s18, 24576
    s_waitcnt vmcnt(39)
    v_lshrrev_b32 v8, v6, s35
    v_and_b32 v8, 0xffff, v8
    v_lshlrev_b32 v9, 16, v8

    v_dot2_f32_bf16 v10, v80, v8, v10
    v_dot2_f32_bf16 v11, v80, v9, v11
    v_dot2_f32_bf16 v12, v81, v8, v12
    v_dot2_f32_bf16 v13, v81, v9, v13
    v_dot2_f32_bf16 v14, v82, v8, v14
    v_dot2_f32_bf16 v15, v82, v9, v15
    buffer_load_dwordx3 v[80:82], v7, s[8:11], s18 offen
    s_add_u32 s18, s18, 24576
    s_waitcnt vmcnt(39)
    v_lshrrev_b32 v8, v6, s36
    v_and_b32 v8, 0xffff, v8
    v_lshlrev_b32 v9, 16, v8

    v_dot2_f32_bf16 v10, v84, v8, v10
    v_dot2_f32_bf16 v11, v84, v9, v11
    v_dot2_f32_bf16 v12, v85, v8, v12
    v_dot2_f32_bf16 v13, v85, v9, v13
    v_dot2_f32_bf16 v14, v86, v8, v14
    v_dot2_f32_bf16 v15, v86, v9, v15
    buffer_load_dwordx3 v[84:86], v7, s[8:11], s18 offen
    s_add_u32 s18, s18, 24576
    s_waitcnt vmcnt(39)
    v_lshrrev_b32 v8, v6, s37
    v_and_b32 v8, 0xffff, v8
    v_lshlrev_b32 v9, 16, v8

    v_dot2_f32_bf16 v10, v88, v8, v10
    v_dot2_f32_bf16 v11, v88, v9, v11
    v_dot2_f32_bf16 v12, v89, v8, v12
    v_dot2_f32_bf16 v13, v89, v9, v13
    v_dot2_f32_bf16 v14, v90, v8, v14
    v_dot2_f32_bf16 v15, v90, v9, v15
    buffer_load_dwordx3 v[88:90], v7, s[8:11], s18 offen
    s_add_u32 s18, s18, 24576
    s_waitcnt vmcnt(39)
    v_lshrrev_b32 v8, v6, s38
    v_and_b32 v8, 0xffff, v8
    v_lshlrev_b32 v9, 16, v8

    v_dot2_f32_bf16 v10, v92, v8, v10
    v_dot2_f32_bf16 v11, v92, v9, v11
    v_dot2_f32_bf16 v12, v93, v8, v12
    v_dot2_f32_bf16 v13, v93, v9, v13
    v_dot2_f32_bf16 v14, v94, v8, v14
    v_dot2_f32_bf16 v15, v94, v9, v15
    buffer_load_dwordx3 v[92:94], v7, s[8:11], s18 offen
    s_add_u32 s18, s18, 24576
    s_waitcnt vmcnt(39)
    v_lshrrev_b32 v8, v6, s39
    v_and_b32 v8, 0xffff, v8
    v_lshlrev_b32 v9, 16, v8

    v_dot2_f32_bf16 v10, v96, v8, v10
    v_dot2_f32_bf16 v11, v96, v9, v11
    v_dot2_f32_bf16 v12, v97, v8, v12
    v_dot2_f32_bf16 v13, v97, v9, v13
    v_dot2_f32_bf16 v14, v98, v8, v14
    v_dot2_f32_bf16 v15, v98, v9, v15
    buffer_load_dwordx3 v[96:98], v7, s[8:11], s18 offen
    s_add_u32 s18, s18, 24576
    s_waitcnt vmcnt(39)
    v_lshrrev_b32 v8, v6, s40
    v_and_b32 v8, 0xffff, v8
    v_lshlrev_b32 v9, 16, v8

    v_dot2_f32_bf16 v10, v100, v8, v10
    v_dot2_f32_bf16 v11, v100, v9, v11
    v_dot2_f32_bf16 v12, v101, v8, v12
    v_dot2_f32_bf16 v13, v101, v9, v13
    v_dot2_f32_bf16 v14, v102, v8, v14
    v_dot2_f32_bf16 v15, v102, v9, v15
    buffer_load_dwordx3 v[100:102], v7, s[8:11], s18 offen
    s_add_u32 s18, s18, 24576
    s_waitcnt vmcnt(39)
    v_lshrrev_b32 v8, v6, s41
    v_and_b32 v8, 0xffff, v8
    v_lshlrev_b32 v9, 16, v8

    v_dot2_f32_bf16 v10, v104, v8, v10
    v_dot2_f32_bf16 v11, v104, v9, v11
    v_dot2_f32_bf16 v12, v105, v8, v12
    v_dot2_f32_bf16 v13, v105, v9, v13
    v_dot2_f32_bf16 v14, v106, v8, v14
    v_dot2_f32_bf16 v15, v106, v9, v15
    buffer_load_dwordx3 v[104:106], v7, s[8:11], s18 offen
    s_add_u32 s18, s18, 24576
    s_waitcnt vmcnt(39)
    v_lshrrev_b32 v8, v6, s42
    v_and_b32 v8, 0xffff, v8
    v_lshlrev_b32 v9, 16, v8

    v_dot2_f32_bf16 v10, v108, v8, v10
    v_dot2_f32_bf16 v11, v108, v9, v11
    v_dot2_f32_bf16 v12, v109, v8, v12
    v_dot2_f32_bf16 v13, v109, v9, v13
    v_dot2_f32_bf16 v14, v110, v8, v14
    v_dot2_f32_bf16 v15, v110, v9, v15
    buffer_load_dwordx3 v[108:110], v7, s[8:11], s18 offen
    s_add_u32 s18, s18, 24576
    s_waitcnt vmcnt(39)
    v_lshrrev_b32 v8, v6, s43
    v_and_b32 v8, 0xffff, v8
    v_lshlrev_b32 v9, 16, v8

    v_dot2_f32_bf16 v10, v112, v8, v10
    v_dot2_f32_bf16 v11, v112, v9, v11
    v_dot2_f32_bf16 v12, v113, v8, v12
    v_dot2_f32_bf16 v13, v113, v9, v13
    v_dot2_f32_bf16 v14, v114, v8, v14
    v_dot2_f32_bf16 v15, v114, v9, v15
    buffer_load_dwordx3 v[112:114], v7, s[8:11], s18 offen
    s_add_u32 s18, s18, 24576
    s_waitcnt vmcnt(39)
    v_lshrrev_b32 v8, v6, s44
    v_and_b32 v8, 0xffff, v8
    v_lshlrev_b32 v9, 16, v8

    v_dot2_f32_bf16 v10, v116, v8, v10
    v_dot2_f32_bf16 v11, v116, v9, v11
    v_dot2_f32_bf16 v12, v117, v8, v12
    v_dot2_f32_bf16 v13, v117, v9, v13
    v_dot2_f32_bf16 v14, v118, v8, v14
    v_dot2_f32_bf16 v15, v118, v9, v15
    buffer_load_dwordx3 v[116:118], v7, s[8:11], s18 offen
    s_add_u32 s18, s18, 24576
    s_waitcnt vmcnt(39)
    v_lshrrev_b32 v8, v6, s45
    v_and_b32 v8, 0xffff, v8
    v_lshlrev_b32 v9, 16, v8

    v_dot2_f32_bf16 v10, v120, v8, v10
    v_dot2_f32_bf16 v11, v120, v9, v11
    v_dot2_f32_bf16 v12, v121, v8, v12
    v_dot2_f32_bf16 v13, v121, v9, v13
    v_dot2_f32_bf16 v14, v122, v8, v14
    v_dot2_f32_bf16 v15, v122, v9, v15
    buffer_load_dwordx3 v[120:122], v7, s[8:11], s18 offen
    s_add_u32 s18, s18, 24576
    s_waitcnt vmcnt(39)
    v_lshrrev_b32 v8, v6, s46
    v_and_b32 v8, 0xffff, v8
    v_lshlrev_b32 v9, 16, v8

    v_dot2_f32_bf16 v10, v124, v8, v10
    v_dot2_f32_bf16 v11, v124, v9, v11
    v_dot2_f32_bf16 v12, v125, v8, v12
    v_dot2_f32_bf16 v13, v125, v9, v13
    v_dot2_f32_bf16 v14, v126, v8, v14
    v_dot2_f32_bf16 v15, v126, v9, v15
    buffer_load_dwordx3 v[124:126], v7, s[8:11], s18 offen
    s_add_u32 s18, s18, 24576
    s_waitcnt vmcnt(39)
    v_lshrrev_b32 v8, v6, s47
    v_and_b32 v8, 0xffff, v8
    v_lshlrev_b32 v9, 16, v8

    v_dot2_f32_bf16 v10, v128, v8, v10
    v_dot2_f32_bf16 v11, v128, v9, v11
    v_dot2_f32_bf16 v12, v129, v8, v12
    v_dot2_f32_bf16 v13, v129, v9, v13
    v_dot2_f32_bf16 v14, v130, v8, v14
    v_dot2_f32_bf16 v15, v130, v9, v15
    buffer_load_dwordx3 v[128:130], v7, s[8:11], s18 offen
    s_add_u32 s18, s18, 24576
    s_waitcnt vmcnt(39)
    v_lshrrev_b32 v8, v6, s48
    v_and_b32 v8, 0xffff, v8
    v_lshlrev_b32 v9, 16, v8

    v_dot2_f32_bf16 v10, v132, v8, v10
    v_dot2_f32_bf16 v11, v132, v9, v11
    v_dot2_f32_bf16 v12, v133, v8, v12
    v_dot2_f32_bf16 v13, v133, v9, v13
    v_dot2_f32_bf16 v14, v134, v8, v14
    v_dot2_f32_bf16 v15, v134, v9, v15
    buffer_load_dwordx3 v[132:134], v7, s[8:11], s18 offen
    s_add_u32 s18, s18, 24576
    s_waitcnt vmcnt(39)
    v_lshrrev_b32 v8, v6, s49
    v_and_b32 v8, 0xffff, v8
    v_lshlrev_b32 v9, 16, v8

    v_dot2_f32_bf16 v10, v136, v8, v10
    v_dot2_f32_bf16 v11, v136, v9, v11
    v_dot2_f32_bf16 v12, v137, v8, v12
    v_dot2_f32_bf16 v13, v137, v9, v13
    v_dot2_f32_bf16 v14, v138, v8, v14
    v_dot2_f32_bf16 v15, v138, v9, v15
    buffer_load_dwordx3 v[136:138], v7, s[8:11], s18 offen
    s_add_u32 s18, s18, 24576
    s_waitcnt vmcnt(39)
    v_lshrrev_b32 v8, v6, s50
    v_and_b32 v8, 0xffff, v8
    v_lshlrev_b32 v9, 16, v8

    v_dot2_f32_bf16 v10, v140, v8, v10
    v_dot2_f32_bf16 v11, v140, v9, v11
    v_dot2_f32_bf16 v12, v141, v8, v12
    v_dot2_f32_bf16 v13, v141, v9, v13
    v_dot2_f32_bf16 v14, v142, v8, v14
    v_dot2_f32_bf16 v15, v142, v9, v15
    buffer_load_dwordx3 v[140:142], v7, s[8:11], s18 offen
    s_add_u32 s18, s18, 24576
    s_waitcnt vmcnt(39)
    v_lshrrev_b32 v8, v6, s51
    v_and_b32 v8, 0xffff, v8
    v_lshlrev_b32 v9, 16, v8

    v_dot2_f32_bf16 v10, v144, v8, v10
    v_dot2_f32_bf16 v11, v144, v9, v11
    v_dot2_f32_bf16 v12, v145, v8, v12
    v_dot2_f32_bf16 v13, v145, v9, v13
    v_dot2_f32_bf16 v14, v146, v8, v14
    v_dot2_f32_bf16 v15, v146, v9, v15
    buffer_load_dwordx3 v[144:146], v7, s[8:11], s18 offen
    s_add_u32 s18, s18, 24576
    s_waitcnt vmcnt(39)
    v_lshrrev_b32 v8, v6, s52
    v_and_b32 v8, 0xffff, v8
    v_lshlrev_b32 v9, 16, v8

    v_dot2_f32_bf16 v10, v148, v8, v10
    v_dot2_f32_bf16 v11, v148, v9, v11
    v_dot2_f32_bf16 v12, v149, v8, v12
    v_dot2_f32_bf16 v13, v149, v9, v13
    v_dot2_f32_bf16 v14, v150, v8, v14
    v_dot2_f32_bf16 v15, v150, v9, v15
    buffer_load_dwordx3 v[148:150], v7, s[8:11], s18 offen
    s_add_u32 s18, s18, 24576
    s_waitcnt vmcnt(39)
    v_lshrrev_b32 v8, v6, s53
    v_and_b32 v8, 0xffff, v8
    v_lshlrev_b32 v9, 16, v8

    v_dot2_f32_bf16 v10, v152, v8, v10
    v_dot2_f32_bf16 v11, v152, v9, v11
    v_dot2_f32_bf16 v12, v153, v8, v12
    v_dot2_f32_bf16 v13, v153, v9, v13
    v_dot2_f32_bf16 v14, v154, v8, v14
    v_dot2_f32_bf16 v15, v154, v9, v15
    buffer_load_dwordx3 v[152:154], v7, s[8:11], s18 offen
    s_add_u32 s18, s18, 24576
    s_waitcnt vmcnt(39)
    v_lshrrev_b32 v8, v6, s54
    v_and_b32 v8, 0xffff, v8
    v_lshlrev_b32 v9, 16, v8

    v_dot2_f32_bf16 v10, v156, v8, v10
    v_dot2_f32_bf16 v11, v156, v9, v11
    v_dot2_f32_bf16 v12, v157, v8, v12
    v_dot2_f32_bf16 v13, v157, v9, v13
    v_dot2_f32_bf16 v14, v158, v8, v14
    v_dot2_f32_bf16 v15, v158, v9, v15
    buffer_load_dwordx3 v[156:158], v7, s[8:11], s18 offen
    s_add_u32 s18, s18, 24576
    s_waitcnt vmcnt(39)
    v_lshrrev_b32 v8, v6, s55
    v_and_b32 v8, 0xffff, v8
    v_lshlrev_b32 v9, 16, v8

    v_dot2_f32_bf16 v10, v160, v8, v10
    v_dot2_f32_bf16 v11, v160, v9, v11
    v_dot2_f32_bf16 v12, v161, v8, v12
    v_dot2_f32_bf16 v13, v161, v9, v13
    v_dot2_f32_bf16 v14, v162, v8, v14
    v_dot2_f32_bf16 v15, v162, v9, v15
    buffer_load_dwordx3 v[160:162], v7, s[8:11], s18 offen
    s_add_u32 s18, s18, 24576
    s_waitcnt vmcnt(39)
    v_lshrrev_b32 v8, v6, s56
    v_and_b32 v8, 0xffff, v8
    v_lshlrev_b32 v9, 16, v8

    v_dot2_f32_bf16 v10, v164, v8, v10
    v_dot2_f32_bf16 v11, v164, v9, v11
    v_dot2_f32_bf16 v12, v165, v8, v12
    v_dot2_f32_bf16 v13, v165, v9, v13
    v_dot2_f32_bf16 v14, v166, v8, v14
    v_dot2_f32_bf16 v15, v166, v9, v15
    buffer_load_dwordx3 v[164:166], v7, s[8:11], s18 offen
    s_add_u32 s18, s18, 24576
    s_waitcnt vmcnt(39)
    v_lshrrev_b32 v8, v6, s57
    v_and_b32 v8, 0xffff, v8
    v_lshlrev_b32 v9, 16, v8

    v_dot2_f32_bf16 v10, v168, v8, v10
    v_dot2_f32_bf16 v11, v168, v9, v11
    v_dot2_f32_bf16 v12, v169, v8, v12
    v_dot2_f32_bf16 v13, v169, v9, v13
    v_dot2_f32_bf16 v14, v170, v8, v14
    v_dot2_f32_bf16 v15, v170, v9, v15
    buffer_load_dwordx3 v[168:170], v7, s[8:11], s18 offen
    s_add_u32 s18, s18, 24576
    s_waitcnt vmcnt(39)
    v_lshrrev_b32 v8, v6, s58
    v_and_b32 v8, 0xffff, v8
    v_lshlrev_b32 v9, 16, v8

    v_dot2_f32_bf16 v10, v172, v8, v10
    v_dot2_f32_bf16 v11, v172, v9, v11
    v_dot2_f32_bf16 v12, v173, v8, v12
    v_dot2_f32_bf16 v13, v173, v9, v13
    v_dot2_f32_bf16 v14, v174, v8, v14
    v_dot2_f32_bf16 v15, v174, v9, v15
    buffer_load_dwordx3 v[172:174], v7, s[8:11], s18 offen
    s_add_u32 s18, s18, 24576
    s_waitcnt vmcnt(39)
    v_lshrrev_b32 v8, v6, s59
    v_and_b32 v8, 0xffff, v8
    v_lshlrev_b32 v9, 16, v8

    v_dot2_f32_bf16 v10, v176, v8, v10
    v_dot2_f32_bf16 v11, v176, v9, v11
    v_dot2_f32_bf16 v12, v177, v8, v12
    v_dot2_f32_bf16 v13, v177, v9, v13
    v_dot2_f32_bf16 v14, v178, v8, v14
    v_dot2_f32_bf16 v15, v178, v9, v15
    buffer_load_dwordx3 v[176:178], v7, s[8:11], s18 offen
    s_add_u32 s18, s18, 24576
    s_waitcnt vmcnt(39)
    v_lshrrev_b32 v8, v6, s60
    v_and_b32 v8, 0xffff, v8
    v_lshlrev_b32 v9, 16, v8

    v_dot2_f32_bf16 v10, v20, v8, v10
    v_dot2_f32_bf16 v11, v20, v9, v11
    v_dot2_f32_bf16 v12, v21, v8, v12
    v_dot2_f32_bf16 v13, v21, v9, v13
    v_dot2_f32_bf16 v14, v22, v8, v14
    v_dot2_f32_bf16 v15, v22, v9, v15
    s_waitcnt vmcnt(38)
    v_lshrrev_b32 v8, v6, s61
    v_and_b32 v8, 0xffff, v8
    v_lshlrev_b32 v9, 16, v8

    v_dot2_f32_bf16 v10, v24, v8, v10
    v_dot2_f32_bf16 v11, v24, v9, v11
    v_dot2_f32_bf16 v12, v25, v8, v12
    v_dot2_f32_bf16 v13, v25, v9, v13
    v_dot2_f32_bf16 v14, v26, v8, v14
    v_dot2_f32_bf16 v15, v26, v9, v15
    s_waitcnt vmcnt(37)
    v_lshrrev_b32 v8, v6, s62
    v_and_b32 v8, 0xffff, v8
    v_lshlrev_b32 v9, 16, v8

    v_dot2_f32_bf16 v10, v28, v8, v10
    v_dot2_f32_bf16 v11, v28, v9, v11
    v_dot2_f32_bf16 v12, v29, v8, v12
    v_dot2_f32_bf16 v13, v29, v9, v13
    v_dot2_f32_bf16 v14, v30, v8, v14
    v_dot2_f32_bf16 v15, v30, v9, v15
    s_waitcnt vmcnt(36)
    v_lshrrev_b32 v8, v6, s63
    v_and_b32 v8, 0xffff, v8
    v_lshlrev_b32 v9, 16, v8

    v_dot2_f32_bf16 v10, v32, v8, v10
    v_dot2_f32_bf16 v11, v32, v9, v11
    v_dot2_f32_bf16 v12, v33, v8, v12
    v_dot2_f32_bf16 v13, v33, v9, v13
    v_dot2_f32_bf16 v14, v34, v8, v14
    v_dot2_f32_bf16 v15, v34, v9, v15
    s_waitcnt vmcnt(35)
    v_lshrrev_b32 v8, v6, s64
    v_and_b32 v8, 0xffff, v8
    v_lshlrev_b32 v9, 16, v8

    v_dot2_f32_bf16 v10, v36, v8, v10
    v_dot2_f32_bf16 v11, v36, v9, v11
    v_dot2_f32_bf16 v12, v37, v8, v12
    v_dot2_f32_bf16 v13, v37, v9, v13
    v_dot2_f32_bf16 v14, v38, v8, v14
    v_dot2_f32_bf16 v15, v38, v9, v15
    s_waitcnt vmcnt(34)
    v_lshrrev_b32 v8, v6, s65
    v_and_b32 v8, 0xffff, v8
    v_lshlrev_b32 v9, 16, v8

    v_dot2_f32_bf16 v10, v40, v8, v10
    v_dot2_f32_bf16 v11, v40, v9, v11
    v_dot2_f32_bf16 v12, v41, v8, v12
    v_dot2_f32_bf16 v13, v41, v9, v13
    v_dot2_f32_bf16 v14, v42, v8, v14
    v_dot2_f32_bf16 v15, v42, v9, v15
    s_waitcnt vmcnt(33)
    v_lshrrev_b32 v8, v6, s66
    v_and_b32 v8, 0xffff, v8
    v_lshlrev_b32 v9, 16, v8

    v_dot2_f32_bf16 v10, v44, v8, v10
    v_dot2_f32_bf16 v11, v44, v9, v11
    v_dot2_f32_bf16 v12, v45, v8, v12
    v_dot2_f32_bf16 v13, v45, v9, v13
    v_dot2_f32_bf16 v14, v46, v8, v14
    v_dot2_f32_bf16 v15, v46, v9, v15
    s_waitcnt vmcnt(32)
    v_lshrrev_b32 v8, v6, s67
    v_and_b32 v8, 0xffff, v8
    v_lshlrev_b32 v9, 16, v8

    v_dot2_f32_bf16 v10, v48, v8, v10
    v_dot2_f32_bf16 v11, v48, v9, v11
    v_dot2_f32_bf16 v12, v49, v8, v12
    v_dot2_f32_bf16 v13, v49, v9, v13
    v_dot2_f32_bf16 v14, v50, v8, v14
    v_dot2_f32_bf16 v15, v50, v9, v15
    s_waitcnt vmcnt(31)
    v_lshrrev_b32 v8, v6, s68
    v_and_b32 v8, 0xffff, v8
    v_lshlrev_b32 v9, 16, v8

    v_dot2_f32_bf16 v10, v52, v8, v10
    v_dot2_f32_bf16 v11, v52, v9, v11
    v_dot2_f32_bf16 v12, v53, v8, v12
    v_dot2_f32_bf16 v13, v53, v9, v13
    v_dot2_f32_bf16 v14, v54, v8, v14
    v_dot2_f32_bf16 v15, v54, v9, v15
    s_waitcnt vmcnt(30)
    v_lshrrev_b32 v8, v6, s69
    v_and_b32 v8, 0xffff, v8
    v_lshlrev_b32 v9, 16, v8

    v_dot2_f32_bf16 v10, v56, v8, v10
    v_dot2_f32_bf16 v11, v56, v9, v11
    v_dot2_f32_bf16 v12, v57, v8, v12
    v_dot2_f32_bf16 v13, v57, v9, v13
    v_dot2_f32_bf16 v14, v58, v8, v14
    v_dot2_f32_bf16 v15, v58, v9, v15
    s_waitcnt vmcnt(29)
    v_lshrrev_b32 v8, v6, s70
    v_and_b32 v8, 0xffff, v8
    v_lshlrev_b32 v9, 16, v8

    v_dot2_f32_bf16 v10, v60, v8, v10
    v_dot2_f32_bf16 v11, v60, v9, v11
    v_dot2_f32_bf16 v12, v61, v8, v12
    v_dot2_f32_bf16 v13, v61, v9, v13
    v_dot2_f32_bf16 v14, v62, v8, v14
    v_dot2_f32_bf16 v15, v62, v9, v15
    s_waitcnt vmcnt(28)
    v_lshrrev_b32 v8, v6, s71
    v_and_b32 v8, 0xffff, v8
    v_lshlrev_b32 v9, 16, v8

    v_dot2_f32_bf16 v10, v64, v8, v10
    v_dot2_f32_bf16 v11, v64, v9, v11
    v_dot2_f32_bf16 v12, v65, v8, v12
    v_dot2_f32_bf16 v13, v65, v9, v13
    v_dot2_f32_bf16 v14, v66, v8, v14
    v_dot2_f32_bf16 v15, v66, v9, v15
    s_waitcnt vmcnt(27)
    v_lshrrev_b32 v8, v6, s72
    v_and_b32 v8, 0xffff, v8
    v_lshlrev_b32 v9, 16, v8

    v_dot2_f32_bf16 v10, v68, v8, v10
    v_dot2_f32_bf16 v11, v68, v9, v11
    v_dot2_f32_bf16 v12, v69, v8, v12
    v_dot2_f32_bf16 v13, v69, v9, v13
    v_dot2_f32_bf16 v14, v70, v8, v14
    v_dot2_f32_bf16 v15, v70, v9, v15
    s_waitcnt vmcnt(26)
    v_lshrrev_b32 v8, v6, s73
    v_and_b32 v8, 0xffff, v8
    v_lshlrev_b32 v9, 16, v8

    v_dot2_f32_bf16 v10, v72, v8, v10
    v_dot2_f32_bf16 v11, v72, v9, v11
    v_dot2_f32_bf16 v12, v73, v8, v12
    v_dot2_f32_bf16 v13, v73, v9, v13
    v_dot2_f32_bf16 v14, v74, v8, v14
    v_dot2_f32_bf16 v15, v74, v9, v15
    s_waitcnt vmcnt(25)
    v_lshrrev_b32 v8, v6, s74
    v_and_b32 v8, 0xffff, v8
    v_lshlrev_b32 v9, 16, v8

    v_dot2_f32_bf16 v10, v76, v8, v10
    v_dot2_f32_bf16 v11, v76, v9, v11
    v_dot2_f32_bf16 v12, v77, v8, v12
    v_dot2_f32_bf16 v13, v77, v9, v13
    v_dot2_f32_bf16 v14, v78, v8, v14
    v_dot2_f32_bf16 v15, v78, v9, v15
    s_waitcnt vmcnt(24)
    v_lshrrev_b32 v8, v6, s75
    v_and_b32 v8, 0xffff, v8
    v_lshlrev_b32 v9, 16, v8

    v_dot2_f32_bf16 v10, v80, v8, v10
    v_dot2_f32_bf16 v11, v80, v9, v11
    v_dot2_f32_bf16 v12, v81, v8, v12
    v_dot2_f32_bf16 v13, v81, v9, v13
    v_dot2_f32_bf16 v14, v82, v8, v14
    v_dot2_f32_bf16 v15, v82, v9, v15
    s_waitcnt vmcnt(23)
    v_lshrrev_b32 v8, v6, s76
    v_and_b32 v8, 0xffff, v8
    v_lshlrev_b32 v9, 16, v8

    v_dot2_f32_bf16 v10, v84, v8, v10
    v_dot2_f32_bf16 v11, v84, v9, v11
    v_dot2_f32_bf16 v12, v85, v8, v12
    v_dot2_f32_bf16 v13, v85, v9, v13
    v_dot2_f32_bf16 v14, v86, v8, v14
    v_dot2_f32_bf16 v15, v86, v9, v15
    s_waitcnt vmcnt(22)
    v_lshrrev_b32 v8, v6, s77
    v_and_b32 v8, 0xffff, v8
    v_lshlrev_b32 v9, 16, v8

    v_dot2_f32_bf16 v10, v88, v8, v10
    v_dot2_f32_bf16 v11, v88, v9, v11
    v_dot2_f32_bf16 v12, v89, v8, v12
    v_dot2_f32_bf16 v13, v89, v9, v13
    v_dot2_f32_bf16 v14, v90, v8, v14
    v_dot2_f32_bf16 v15, v90, v9, v15
    s_waitcnt vmcnt(21)
    v_lshrrev_b32 v8, v6, s78
    v_and_b32 v8, 0xffff, v8
    v_lshlrev_b32 v9, 16, v8

    v_dot2_f32_bf16 v10, v92, v8, v10
    v_dot2_f32_bf16 v11, v92, v9, v11
    v_dot2_f32_bf16 v12, v93, v8, v12
    v_dot2_f32_bf16 v13, v93, v9, v13
    v_dot2_f32_bf16 v14, v94, v8, v14
    v_dot2_f32_bf16 v15, v94, v9, v15
    s_waitcnt vmcnt(20)
    v_lshrrev_b32 v8, v6, s79
    v_and_b32 v8, 0xffff, v8
    v_lshlrev_b32 v9, 16, v8

    v_dot2_f32_bf16 v10, v96, v8, v10
    v_dot2_f32_bf16 v11, v96, v9, v11
    v_dot2_f32_bf16 v12, v97, v8, v12
    v_dot2_f32_bf16 v13, v97, v9, v13
    v_dot2_f32_bf16 v14, v98, v8, v14
    v_dot2_f32_bf16 v15, v98, v9, v15
    s_waitcnt vmcnt(19)
    v_lshrrev_b32 v8, v6, s80
    v_and_b32 v8, 0xffff, v8
    v_lshlrev_b32 v9, 16, v8

    v_dot2_f32_bf16 v10, v100, v8, v10
    v_dot2_f32_bf16 v11, v100, v9, v11
    v_dot2_f32_bf16 v12, v101, v8, v12
    v_dot2_f32_bf16 v13, v101, v9, v13
    v_dot2_f32_bf16 v14, v102, v8, v14
    v_dot2_f32_bf16 v15, v102, v9, v15
    s_waitcnt vmcnt(18)
    v_lshrrev_b32 v8, v6, s81
    v_and_b32 v8, 0xffff, v8
    v_lshlrev_b32 v9, 16, v8

    v_dot2_f32_bf16 v10, v104, v8, v10
    v_dot2_f32_bf16 v11, v104, v9, v11
    v_dot2_f32_bf16 v12, v105, v8, v12
    v_dot2_f32_bf16 v13, v105, v9, v13
    v_dot2_f32_bf16 v14, v106, v8, v14
    v_dot2_f32_bf16 v15, v106, v9, v15
    s_waitcnt vmcnt(17)
    v_lshrrev_b32 v8, v6, s82
    v_and_b32 v8, 0xffff, v8
    v_lshlrev_b32 v9, 16, v8

    v_dot2_f32_bf16 v10, v108, v8, v10
    v_dot2_f32_bf16 v11, v108, v9, v11
    v_dot2_f32_bf16 v12, v109, v8, v12
    v_dot2_f32_bf16 v13, v109, v9, v13
    v_dot2_f32_bf16 v14, v110, v8, v14
    v_dot2_f32_bf16 v15, v110, v9, v15
    s_waitcnt vmcnt(16)
    v_lshrrev_b32 v8, v6, s83
    v_and_b32 v8, 0xffff, v8
    v_lshlrev_b32 v9, 16, v8

    v_dot2_f32_bf16 v10, v112, v8, v10
    v_dot2_f32_bf16 v11, v112, v9, v11
    v_dot2_f32_bf16 v12, v113, v8, v12
    v_dot2_f32_bf16 v13, v113, v9, v13
    v_dot2_f32_bf16 v14, v114, v8, v14
    v_dot2_f32_bf16 v15, v114, v9, v15
    s_waitcnt vmcnt(15)
    v_lshrrev_b32 v8, v6, s84
    v_and_b32 v8, 0xffff, v8
    v_lshlrev_b32 v9, 16, v8

    v_dot2_f32_bf16 v10, v116, v8, v10
    v_dot2_f32_bf16 v11, v116, v9, v11
    v_dot2_f32_bf16 v12, v117, v8, v12
    v_dot2_f32_bf16 v13, v117, v9, v13
    v_dot2_f32_bf16 v14, v118, v8, v14
    v_dot2_f32_bf16 v15, v118, v9, v15
    s_waitcnt vmcnt(14)
    v_lshrrev_b32 v8, v6, s85
    v_and_b32 v8, 0xffff, v8
    v_lshlrev_b32 v9, 16, v8

    v_dot2_f32_bf16 v10, v120, v8, v10
    v_dot2_f32_bf16 v11, v120, v9, v11
    v_dot2_f32_bf16 v12, v121, v8, v12
    v_dot2_f32_bf16 v13, v121, v9, v13
    v_dot2_f32_bf16 v14, v122, v8, v14
    v_dot2_f32_bf16 v15, v122, v9, v15
    s_waitcnt vmcnt(13)
    v_lshrrev_b32 v8, v6, s86
    v_and_b32 v8, 0xffff, v8
    v_lshlrev_b32 v9, 16, v8

    v_dot2_f32_bf16 v10, v124, v8, v10
    v_dot2_f32_bf16 v11, v124, v9, v11
    v_dot2_f32_bf16 v12, v125, v8, v12
    v_dot2_f32_bf16 v13, v125, v9, v13
    v_dot2_f32_bf16 v14, v126, v8, v14
    v_dot2_f32_bf16 v15, v126, v9, v15
    s_waitcnt vmcnt(12)
    v_lshrrev_b32 v8, v6, s87
    v_and_b32 v8, 0xffff, v8
    v_lshlrev_b32 v9, 16, v8

    v_dot2_f32_bf16 v10, v128, v8, v10
    v_dot2_f32_bf16 v11, v128, v9, v11
    v_dot2_f32_bf16 v12, v129, v8, v12
    v_dot2_f32_bf16 v13, v129, v9, v13
    v_dot2_f32_bf16 v14, v130, v8, v14
    v_dot2_f32_bf16 v15, v130, v9, v15
    s_waitcnt vmcnt(11)
    v_lshrrev_b32 v8, v6, s88
    v_and_b32 v8, 0xffff, v8
    v_lshlrev_b32 v9, 16, v8

    v_dot2_f32_bf16 v10, v132, v8, v10
    v_dot2_f32_bf16 v11, v132, v9, v11
    v_dot2_f32_bf16 v12, v133, v8, v12
    v_dot2_f32_bf16 v13, v133, v9, v13
    v_dot2_f32_bf16 v14, v134, v8, v14
    v_dot2_f32_bf16 v15, v134, v9, v15
    s_waitcnt vmcnt(10)
    v_lshrrev_b32 v8, v6, s89
    v_and_b32 v8, 0xffff, v8
    v_lshlrev_b32 v9, 16, v8

    v_dot2_f32_bf16 v10, v136, v8, v10
    v_dot2_f32_bf16 v11, v136, v9, v11
    v_dot2_f32_bf16 v12, v137, v8, v12
    v_dot2_f32_bf16 v13, v137, v9, v13
    v_dot2_f32_bf16 v14, v138, v8, v14
    v_dot2_f32_bf16 v15, v138, v9, v15
    s_waitcnt vmcnt(9)
    v_lshrrev_b32 v8, v6, s90
    v_and_b32 v8, 0xffff, v8
    v_lshlrev_b32 v9, 16, v8

    v_dot2_f32_bf16 v10, v140, v8, v10
    v_dot2_f32_bf16 v11, v140, v9, v11
    v_dot2_f32_bf16 v12, v141, v8, v12
    v_dot2_f32_bf16 v13, v141, v9, v13
    v_dot2_f32_bf16 v14, v142, v8, v14
    v_dot2_f32_bf16 v15, v142, v9, v15
    s_waitcnt vmcnt(8)
    v_lshrrev_b32 v8, v6, s91
    v_and_b32 v8, 0xffff, v8
    v_lshlrev_b32 v9, 16, v8

    v_dot2_f32_bf16 v10, v144, v8, v10
    v_dot2_f32_bf16 v11, v144, v9, v11
    v_dot2_f32_bf16 v12, v145, v8, v12
    v_dot2_f32_bf16 v13, v145, v9, v13
    v_dot2_f32_bf16 v14, v146, v8, v14
    v_dot2_f32_bf16 v15, v146, v9, v15
    s_waitcnt vmcnt(7)
    v_lshrrev_b32 v8, v6, s92
    v_and_b32 v8, 0xffff, v8
    v_lshlrev_b32 v9, 16, v8

    v_dot2_f32_bf16 v10, v148, v8, v10
    v_dot2_f32_bf16 v11, v148, v9, v11
    v_dot2_f32_bf16 v12, v149, v8, v12
    v_dot2_f32_bf16 v13, v149, v9, v13
    v_dot2_f32_bf16 v14, v150, v8, v14
    v_dot2_f32_bf16 v15, v150, v9, v15
    s_waitcnt vmcnt(6)
    v_lshrrev_b32 v8, v6, s93
    v_and_b32 v8, 0xffff, v8
    v_lshlrev_b32 v9, 16, v8

    v_dot2_f32_bf16 v10, v152, v8, v10
    v_dot2_f32_bf16 v11, v152, v9, v11
    v_dot2_f32_bf16 v12, v153, v8, v12
    v_dot2_f32_bf16 v13, v153, v9, v13
    v_dot2_f32_bf16 v14, v154, v8, v14
    v_dot2_f32_bf16 v15, v154, v9, v15
    s_waitcnt vmcnt(5)
    v_lshrrev_b32 v8, v6, s94
    v_and_b32 v8, 0xffff, v8
    v_lshlrev_b32 v9, 16, v8

    v_dot2_f32_bf16 v10, v156, v8, v10
    v_dot2_f32_bf16 v11, v156, v9, v11
    v_dot2_f32_bf16 v12, v157, v8, v12
    v_dot2_f32_bf16 v13, v157, v9, v13
    v_dot2_f32_bf16 v14, v158, v8, v14
    v_dot2_f32_bf16 v15, v158, v9, v15
    s_waitcnt vmcnt(4)
    v_lshrrev_b32 v8, v6, s95
    v_and_b32 v8, 0xffff, v8
    v_lshlrev_b32 v9, 16, v8

    v_dot2_f32_bf16 v10, v160, v8, v10
    v_dot2_f32_bf16 v11, v160, v9, v11
    v_dot2_f32_bf16 v12, v161, v8, v12
    v_dot2_f32_bf16 v13, v161, v9, v13
    v_dot2_f32_bf16 v14, v162, v8, v14
    v_dot2_f32_bf16 v15, v162, v9, v15
    s_waitcnt vmcnt(3)
    v_lshrrev_b32 v8, v6, s96
    v_and_b32 v8, 0xffff, v8
    v_lshlrev_b32 v9, 16, v8

    v_dot2_f32_bf16 v10, v164, v8, v10
    v_dot2_f32_bf16 v11, v164, v9, v11
    v_dot2_f32_bf16 v12, v165, v8, v12
    v_dot2_f32_bf16 v13, v165, v9, v13
    v_dot2_f32_bf16 v14, v166, v8, v14
    v_dot2_f32_bf16 v15, v166, v9, v15
    s_waitcnt vmcnt(2)
    v_lshrrev_b32 v8, v6, s97
    v_and_b32 v8, 0xffff, v8
    v_lshlrev_b32 v9, 16, v8

    v_dot2_f32_bf16 v10, v168, v8, v10
    v_dot2_f32_bf16 v11, v168, v9, v11
    v_dot2_f32_bf16 v12, v169, v8, v12
    v_dot2_f32_bf16 v13, v169, v9, v13
    v_dot2_f32_bf16 v14, v170, v8, v14
    v_dot2_f32_bf16 v15, v170, v9, v15
    s_waitcnt vmcnt(1)
    v_lshrrev_b32 v8, v6, s98
    v_and_b32 v8, 0xffff, v8
    v_lshlrev_b32 v9, 16, v8

    v_dot2_f32_bf16 v10, v172, v8, v10
    v_dot2_f32_bf16 v11, v172, v9, v11
    v_dot2_f32_bf16 v12, v173, v8, v12
    v_dot2_f32_bf16 v13, v173, v9, v13
    v_dot2_f32_bf16 v14, v174, v8, v14
    v_dot2_f32_bf16 v15, v174, v9, v15
    s_waitcnt vmcnt(0)
    v_lshrrev_b32 v8, v6, s99
    v_and_b32 v8, 0xffff, v8
    v_lshlrev_b32 v9, 16, v8

    v_dot2_f32_bf16 v10, v176, v8, v10
    v_dot2_f32_bf16 v11, v176, v9, v11
    v_dot2_f32_bf16 v12, v177, v8, v12
    v_dot2_f32_bf16 v13, v177, v9, v13
    v_dot2_f32_bf16 v14, v178, v8, v14
    v_dot2_f32_bf16 v15, v178, v9, v15
    s_mov_b32 s8, s14
    s_and_b32 s9, s15, 0xffff
    s_mov_b32 s10, 9437184
    s_mov_b32 s11, 0x00020000

    s_mul_i32 s16, s7, 96
    s_mul_i32 s17, s3, 24
    s_add_u32 s16, s16, s17
    s_mul_i32 s18, s16, 12288
    s_add_u32 s18, s18, s19

    buffer_load_dwordx3 v[40:42], v7, s[8:11], s18 offen
    s_add_u32 s18, s18, 24576
    buffer_load_dwordx3 v[44:46], v7, s[8:11], s18 offen
    s_add_u32 s18, s18, 24576
    buffer_load_dwordx3 v[48:50], v7, s[8:11], s18 offen
    s_add_u32 s18, s18, 24576
    buffer_load_dwordx3 v[52:54], v7, s[8:11], s18 offen
    s_add_u32 s18, s18, 24576
    buffer_load_dwordx3 v[56:58], v7, s[8:11], s18 offen
    s_add_u32 s18, s18, 24576
    buffer_load_dwordx3 v[60:62], v7, s[8:11], s18 offen
    s_add_u32 s18, s18, 24576
    buffer_load_dwordx3 v[64:66], v7, s[8:11], s18 offen
    s_add_u32 s18, s18, 24576
    buffer_load_dwordx3 v[68:70], v7, s[8:11], s18 offen
    s_add_u32 s18, s18, 24576
    buffer_load_dwordx3 v[72:74], v7, s[8:11], s18 offen
    s_add_u32 s18, s18, 24576
    buffer_load_dwordx3 v[76:78], v7, s[8:11], s18 offen
    s_add_u32 s18, s18, 24576
    buffer_load_dwordx3 v[80:82], v7, s[8:11], s18 offen
    s_add_u32 s18, s18, 24576
    buffer_load_dwordx3 v[84:86], v7, s[8:11], s18 offen
    v_lshlrev_b32 v16, 1, v1
    v_add_u32 v16, v16, v3
    v_mul_u32_u24 v16, 768, v16
    v_lshlrev_b32 v17, 1, v5
    v_add_u32 v16, v16, v17
    ds_write_b64 v16, v[10:11]
    ds_write_b64 v16, v[12:13] offset:8
    ds_write_b64 v16, v[14:15] offset:16
    s_waitcnt lgkmcnt(0)
    s_barrier
    v_cmp_gt_u32 vcc, 192, v0
    s_and_saveexec_b64 s[20:21], vcc
    s_cbranch_execz prep_B2
    v_lshlrev_b32 v16, 2, v0
    ds_read_b32 v20, v16
    ds_read_b32 v21, v16 offset:768
    ds_read_b32 v22, v16 offset:1536
    ds_read_b32 v23, v16 offset:2304
    ds_read_b32 v24, v16 offset:3072
    ds_read_b32 v25, v16 offset:3840
    ds_read_b32 v26, v16 offset:4608
    ds_read_b32 v27, v16 offset:5376
    s_waitcnt lgkmcnt(0)
    v_add_f32 v20, v20, v21
    v_add_f32 v22, v22, v23
    v_add_f32 v24, v24, v25
    v_add_f32 v26, v26, v27
    v_add_f32 v20, v20, v22
    v_add_f32 v24, v24, v26
    v_add_f32 v20, v20, v24
    v_cvt_pk_bf16_f32 v20, v20, v20
    v_lshlrev_b32 v16, 1, v0
    ds_write_b16 v16, v20 offset:8192

prep_B2:
    s_mov_b64 exec, -1
    s_waitcnt lgkmcnt(0)
    s_barrier
    ds_read_b32 v20, v5 offset:8192
    ds_read_b32 v21, v5 offset:8196
    ds_read_b32 v22, v5 offset:8200
    s_waitcnt lgkmcnt(0)

    s_waitcnt vmcnt(11)
    v_mov_b32 v43, 0
    v_dot2_f32_bf16 v43, v40, v20, v43
    v_dot2_f32_bf16 v43, v41, v21, v43
    v_dot2_f32_bf16 v43, v42, v22, v43

    s_waitcnt vmcnt(10)
    v_mov_b32 v47, 0
    v_dot2_f32_bf16 v47, v44, v20, v47
    v_dot2_f32_bf16 v47, v45, v21, v47
    v_dot2_f32_bf16 v47, v46, v22, v47

    s_waitcnt vmcnt(9)
    v_mov_b32 v51, 0
    v_dot2_f32_bf16 v51, v48, v20, v51
    v_dot2_f32_bf16 v51, v49, v21, v51
    v_dot2_f32_bf16 v51, v50, v22, v51

    s_waitcnt vmcnt(8)
    v_mov_b32 v55, 0
    v_dot2_f32_bf16 v55, v52, v20, v55
    v_dot2_f32_bf16 v55, v53, v21, v55
    v_dot2_f32_bf16 v55, v54, v22, v55

    s_waitcnt vmcnt(7)
    v_mov_b32 v59, 0
    v_dot2_f32_bf16 v59, v56, v20, v59
    v_dot2_f32_bf16 v59, v57, v21, v59
    v_dot2_f32_bf16 v59, v58, v22, v59

    s_waitcnt vmcnt(6)
    v_mov_b32 v63, 0
    v_dot2_f32_bf16 v63, v60, v20, v63
    v_dot2_f32_bf16 v63, v61, v21, v63
    v_dot2_f32_bf16 v63, v62, v22, v63

    s_waitcnt vmcnt(5)
    v_mov_b32 v67, 0
    v_dot2_f32_bf16 v67, v64, v20, v67
    v_dot2_f32_bf16 v67, v65, v21, v67
    v_dot2_f32_bf16 v67, v66, v22, v67

    s_waitcnt vmcnt(4)
    v_mov_b32 v71, 0
    v_dot2_f32_bf16 v71, v68, v20, v71
    v_dot2_f32_bf16 v71, v69, v21, v71
    v_dot2_f32_bf16 v71, v70, v22, v71

    s_waitcnt vmcnt(3)
    v_mov_b32 v75, 0
    v_dot2_f32_bf16 v75, v72, v20, v75
    v_dot2_f32_bf16 v75, v73, v21, v75
    v_dot2_f32_bf16 v75, v74, v22, v75

    s_waitcnt vmcnt(2)
    v_mov_b32 v79, 0
    v_dot2_f32_bf16 v79, v76, v20, v79
    v_dot2_f32_bf16 v79, v77, v21, v79
    v_dot2_f32_bf16 v79, v78, v22, v79

    s_waitcnt vmcnt(1)
    v_mov_b32 v83, 0
    v_dot2_f32_bf16 v83, v80, v20, v83
    v_dot2_f32_bf16 v83, v81, v21, v83
    v_dot2_f32_bf16 v83, v82, v22, v83

    s_waitcnt vmcnt(0)
    v_mov_b32 v87, 0
    v_dot2_f32_bf16 v87, v84, v20, v87
    v_dot2_f32_bf16 v87, v85, v21, v87
    v_dot2_f32_bf16 v87, v86, v22, v87

    s_nop 1
    v_add_f32_dpp v43, v43, v43 quad_perm:[1,0,3,2] row_mask:0xf bank_mask:0xf
    v_add_f32_dpp v47, v47, v47 quad_perm:[1,0,3,2] row_mask:0xf bank_mask:0xf
    v_add_f32_dpp v51, v51, v51 quad_perm:[1,0,3,2] row_mask:0xf bank_mask:0xf
    v_add_f32_dpp v55, v55, v55 quad_perm:[1,0,3,2] row_mask:0xf bank_mask:0xf
    v_add_f32_dpp v59, v59, v59 quad_perm:[1,0,3,2] row_mask:0xf bank_mask:0xf
    v_add_f32_dpp v63, v63, v63 quad_perm:[1,0,3,2] row_mask:0xf bank_mask:0xf
    v_add_f32_dpp v67, v67, v67 quad_perm:[1,0,3,2] row_mask:0xf bank_mask:0xf
    v_add_f32_dpp v71, v71, v71 quad_perm:[1,0,3,2] row_mask:0xf bank_mask:0xf
    v_add_f32_dpp v75, v75, v75 quad_perm:[1,0,3,2] row_mask:0xf bank_mask:0xf
    v_add_f32_dpp v79, v79, v79 quad_perm:[1,0,3,2] row_mask:0xf bank_mask:0xf
    v_add_f32_dpp v83, v83, v83 quad_perm:[1,0,3,2] row_mask:0xf bank_mask:0xf
    v_add_f32_dpp v87, v87, v87 quad_perm:[1,0,3,2] row_mask:0xf bank_mask:0xf
    v_add_f32_dpp v43, v43, v43 quad_perm:[2,3,0,1] row_mask:0xf bank_mask:0xf
    v_add_f32_dpp v47, v47, v47 quad_perm:[2,3,0,1] row_mask:0xf bank_mask:0xf
    v_add_f32_dpp v51, v51, v51 quad_perm:[2,3,0,1] row_mask:0xf bank_mask:0xf
    v_add_f32_dpp v55, v55, v55 quad_perm:[2,3,0,1] row_mask:0xf bank_mask:0xf
    v_add_f32_dpp v59, v59, v59 quad_perm:[2,3,0,1] row_mask:0xf bank_mask:0xf
    v_add_f32_dpp v63, v63, v63 quad_perm:[2,3,0,1] row_mask:0xf bank_mask:0xf
    v_add_f32_dpp v67, v67, v67 quad_perm:[2,3,0,1] row_mask:0xf bank_mask:0xf
    v_add_f32_dpp v71, v71, v71 quad_perm:[2,3,0,1] row_mask:0xf bank_mask:0xf
    v_add_f32_dpp v75, v75, v75 quad_perm:[2,3,0,1] row_mask:0xf bank_mask:0xf
    v_add_f32_dpp v79, v79, v79 quad_perm:[2,3,0,1] row_mask:0xf bank_mask:0xf
    v_add_f32_dpp v83, v83, v83 quad_perm:[2,3,0,1] row_mask:0xf bank_mask:0xf
    v_add_f32_dpp v87, v87, v87 quad_perm:[2,3,0,1] row_mask:0xf bank_mask:0xf
    v_add_f32_dpp v43, v43, v43 row_half_mirror row_mask:0xf bank_mask:0xf
    v_add_f32_dpp v47, v47, v47 row_half_mirror row_mask:0xf bank_mask:0xf
    v_add_f32_dpp v51, v51, v51 row_half_mirror row_mask:0xf bank_mask:0xf
    v_add_f32_dpp v55, v55, v55 row_half_mirror row_mask:0xf bank_mask:0xf
    v_add_f32_dpp v59, v59, v59 row_half_mirror row_mask:0xf bank_mask:0xf
    v_add_f32_dpp v63, v63, v63 row_half_mirror row_mask:0xf bank_mask:0xf
    v_add_f32_dpp v67, v67, v67 row_half_mirror row_mask:0xf bank_mask:0xf
    v_add_f32_dpp v71, v71, v71 row_half_mirror row_mask:0xf bank_mask:0xf
    v_add_f32_dpp v75, v75, v75 row_half_mirror row_mask:0xf bank_mask:0xf
    v_add_f32_dpp v79, v79, v79 row_half_mirror row_mask:0xf bank_mask:0xf
    v_add_f32_dpp v83, v83, v83 row_half_mirror row_mask:0xf bank_mask:0xf
    v_add_f32_dpp v87, v87, v87 row_half_mirror row_mask:0xf bank_mask:0xf
    v_add_f32_dpp v43, v43, v43 row_mirror row_mask:0xf bank_mask:0xf
    v_add_f32_dpp v47, v47, v47 row_mirror row_mask:0xf bank_mask:0xf
    v_add_f32_dpp v51, v51, v51 row_mirror row_mask:0xf bank_mask:0xf
    v_add_f32_dpp v55, v55, v55 row_mirror row_mask:0xf bank_mask:0xf
    v_add_f32_dpp v59, v59, v59 row_mirror row_mask:0xf bank_mask:0xf
    v_add_f32_dpp v63, v63, v63 row_mirror row_mask:0xf bank_mask:0xf
    v_add_f32_dpp v67, v67, v67 row_mirror row_mask:0xf bank_mask:0xf
    v_add_f32_dpp v71, v71, v71 row_mirror row_mask:0xf bank_mask:0xf
    v_add_f32_dpp v75, v75, v75 row_mirror row_mask:0xf bank_mask:0xf
    v_add_f32_dpp v79, v79, v79 row_mirror row_mask:0xf bank_mask:0xf
    v_add_f32_dpp v83, v83, v83 row_mirror row_mask:0xf bank_mask:0xf
    v_add_f32_dpp v87, v87, v87 row_mirror row_mask:0xf bank_mask:0xf
    v_mov_b32 v100, v43
    v_mov_b32 v101, v47
    v_mov_b32 v102, v51
    v_mov_b32 v103, v55
    v_mov_b32 v104, v59
    v_mov_b32 v105, v63
    v_mov_b32 v106, v67
    v_mov_b32 v107, v71
    v_mov_b32 v108, v75
    v_mov_b32 v109, v79
    v_mov_b32 v110, v83
    v_mov_b32 v111, v87
    s_nop 1
    v_permlane16_swap_b32 v100, v43
    v_permlane16_swap_b32 v101, v47
    v_permlane16_swap_b32 v102, v51
    v_permlane16_swap_b32 v103, v55
    v_permlane16_swap_b32 v104, v59
    v_permlane16_swap_b32 v105, v63
    v_permlane16_swap_b32 v106, v67
    v_permlane16_swap_b32 v107, v71
    v_permlane16_swap_b32 v108, v75
    v_permlane16_swap_b32 v109, v79
    v_permlane16_swap_b32 v110, v83
    v_permlane16_swap_b32 v111, v87
    s_nop 1
    v_add_f32 v43, v43, v100
    v_add_f32 v47, v47, v101
    v_add_f32 v51, v51, v102
    v_add_f32 v55, v55, v103
    v_add_f32 v59, v59, v104
    v_add_f32 v63, v63, v105
    v_add_f32 v67, v67, v106
    v_add_f32 v71, v71, v107
    v_add_f32 v75, v75, v108
    v_add_f32 v79, v79, v109
    v_add_f32 v83, v83, v110
    v_add_f32 v87, v87, v111
    s_mov_b32 s8, s4
    s_and_b32 s9, s5, 0xffff
    s_mov_b32 s10, 8388608
    s_mov_b32 s11, 0x00020000

    s_mul_i32 s16, s6, 1536
    s_mul_i32 s17, s7, 192
    s_add_u32 s16, s16, s17
    s_mul_i32 s17, s3, 48
    s_add_u32 s16, s16, s17
    s_add_u32 s16, s16, 196608
    v_lshlrev_b32 v16, 1, v3
    s_mov_b32 s20, 1
    s_mov_b32 s21, 1

    v_cvt_pk_bf16_f32 v43, v43, v43
    v_cvt_pk_bf16_f32 v47, v47, v47
    v_cvt_pk_bf16_f32 v51, v51, v51
    v_cvt_pk_bf16_f32 v55, v55, v55
    v_cvt_pk_bf16_f32 v59, v59, v59
    v_cvt_pk_bf16_f32 v63, v63, v63
    v_cvt_pk_bf16_f32 v67, v67, v67
    v_cvt_pk_bf16_f32 v71, v71, v71
    v_cvt_pk_bf16_f32 v75, v75, v75
    v_cvt_pk_bf16_f32 v79, v79, v79
    v_cvt_pk_bf16_f32 v83, v83, v83
    v_cvt_pk_bf16_f32 v87, v87, v87
    s_mov_b64 exec, s[20:21]
    buffer_store_short v43, v16, s[8:11], s16 offen offset:0
    buffer_store_short v47, v16, s[8:11], s16 offen offset:4
    buffer_store_short v51, v16, s[8:11], s16 offen offset:8
    buffer_store_short v55, v16, s[8:11], s16 offen offset:12
    buffer_store_short v59, v16, s[8:11], s16 offen offset:16
    buffer_store_short v63, v16, s[8:11], s16 offen offset:20
    buffer_store_short v67, v16, s[8:11], s16 offen offset:24
    buffer_store_short v71, v16, s[8:11], s16 offen offset:28
    buffer_store_short v75, v16, s[8:11], s16 offen offset:32
    buffer_store_short v79, v16, s[8:11], s16 offen offset:36
    buffer_store_short v83, v16, s[8:11], s16 offen offset:40
    buffer_store_short v87, v16, s[8:11], s16 offen offset:44
prep_exit:
    s_endpgm
.p2align 8
.type attn_kernel,@function
attn_kernel:
    s_cmp_ge_u32 s2, 384
    s_cbranch_scc1 attn_exit
    s_load_dwordx2 s[4:5], s[0:1], 104
    v_lshrrev_b32 v1, 6, v0
    s_nop 0
    v_readfirstlane_b32 s3, v1
    v_and_b32 v2, 63, v0
    v_lshrrev_b32 v3, 5, v2
    v_and_b32 v4, 31, v2
    s_cmp_lt_u32 s2, 128
    s_cbranch_scc1 attn_B

    s_load_dwordx2 s[12:13], s[0:1], 8
    s_load_dwordx2 s[14:15], s[0:1], 16
    s_sub_u32 s7, s2, 128
    s_and_b32 s6, s7, 31
    s_lshr_b32 s7, s7, 5
    v_mul_u32_u24 v5, 12, v4
    s_waitcnt lgkmcnt(0)

    s_mov_b32 s8, s4
    s_and_b32 s9, s5, 0xffff
    s_mov_b32 s10, 8388608
    s_mov_b32 s11, 0x00020000

    s_mov_b32 s16, s12
    s_and_b32 s17, s13, 0xffff
    s_mov_b32 s18, 100663296
    s_mov_b32 s19, 0x00020000

    s_mov_b32 s20, s14
    s_and_b32 s21, s15, 0xffff
    s_mov_b32 s22, 100663296
    s_mov_b32 s23, 0x00020000

    s_mul_i32 s24, s6, 768
    v_lshlrev_b32 v18, 1, v5

    buffer_load_dwordx3 v[32:34], v18, s[8:11], s24 offen
    buffer_load_dwordx3 v[36:38], v18, s[8:11], s24 offen offset:12
    s_add_u32 s24, s24, 24576
    buffer_load_dwordx3 v[40:42], v18, s[8:11], s24 offen
    buffer_load_dwordx3 v[44:46], v18, s[8:11], s24 offen offset:12
    s_add_u32 s24, s24, 24576
    buffer_load_dwordx3 v[48:50], v18, s[8:11], s24 offen
    buffer_load_dwordx3 v[52:54], v18, s[8:11], s24 offen offset:12
    s_add_u32 s24, s24, 24576
    buffer_load_dwordx3 v[56:58], v18, s[8:11], s24 offen
    buffer_load_dwordx3 v[60:62], v18, s[8:11], s24 offen offset:12
    s_add_u32 s24, s24, 24576
    buffer_load_dwordx3 v[64:66], v18, s[8:11], s24 offen
    buffer_load_dwordx3 v[68:70], v18, s[8:11], s24 offen offset:12
    s_add_u32 s24, s24, 24576
    buffer_load_dwordx3 v[72:74], v18, s[8:11], s24 offen
    buffer_load_dwordx3 v[76:78], v18, s[8:11], s24 offen offset:12
    s_add_u32 s24, s24, 24576
    buffer_load_dwordx3 v[80:82], v18, s[8:11], s24 offen
    buffer_load_dwordx3 v[84:86], v18, s[8:11], s24 offen offset:12
    s_add_u32 s24, s24, 24576
    buffer_load_dwordx3 v[88:90], v18, s[8:11], s24 offen
    buffer_load_dwordx3 v[92:94], v18, s[8:11], s24 offen offset:12
    s_add_u32 s24, s24, 24576
    s_lshl_b32 s25, s6, 13
    s_mul_i32 s26, s7, 1024
    s_add_u32 s25, s25, s26
    s_mul_i32 s26, s3, 256
    s_add_u32 s25, s25, s26
    s_mul_i32 s25, s25, 384
    v_mul_u32_u24 v19, 384, v3
    v_add_u32 v19, v19, v5
    v_add_u32 v20, 4608, v19
    s_waitcnt vmcnt(0)

    v_add_f32 v32, v32, v40
    v_add_f32 v36, v36, v44
    v_add_f32 v33, v33, v41
    v_add_f32 v37, v37, v45
    v_add_f32 v34, v34, v42
    v_add_f32 v38, v38, v46
    v_add_f32 v32, v32, v48
    v_add_f32 v36, v36, v52
    v_add_f32 v33, v33, v49
    v_add_f32 v37, v37, v53
    v_add_f32 v34, v34, v50
    v_add_f32 v38, v38, v54
    v_add_f32 v32, v32, v56
    v_add_f32 v36, v36, v60
    v_add_f32 v33, v33, v57
    v_add_f32 v37, v37, v61
    v_add_f32 v34, v34, v58
    v_add_f32 v38, v38, v62
    v_add_f32 v32, v32, v64
    v_add_f32 v36, v36, v68
    v_add_f32 v33, v33, v65
    v_add_f32 v37, v37, v69
    v_add_f32 v34, v34, v66
    v_add_f32 v38, v38, v70
    v_add_f32 v32, v32, v72
    v_add_f32 v36, v36, v76
    v_add_f32 v33, v33, v73
    v_add_f32 v37, v37, v77
    v_add_f32 v34, v34, v74
    v_add_f32 v38, v38, v78
    v_add_f32 v32, v32, v80
    v_add_f32 v36, v36, v84
    v_add_f32 v33, v33, v81
    v_add_f32 v37, v37, v85
    v_add_f32 v34, v34, v82
    v_add_f32 v38, v38, v86
    v_add_f32 v32, v32, v88
    v_add_f32 v36, v36, v92
    v_add_f32 v33, v33, v89
    v_add_f32 v37, v37, v93
    v_add_f32 v34, v34, v90
    v_add_f32 v38, v38, v94
    v_cvt_pk_bf16_f32 v6, v32, v33
    v_cvt_pk_bf16_f32 v7, v34, v36
    v_cvt_pk_bf16_f32 v8, v37, v38
    v_mov_b32 v9, 0xf149f2ca
    v_mov_b32 v10, 0
    s_mov_b32 s27, 1037384597

    v_mov_b32 v12, 0
    v_mov_b32 v13, 0
    v_mov_b32 v14, 0
    v_mov_b32 v15, 0
    v_mov_b32 v16, 0
    v_mov_b32 v17, 0
    buffer_load_dwordx3 v[32:34], v19, s[16:19], s25 offen offset:0 nt
    buffer_load_dwordx3 v[36:38], v19, s[16:19], s25 offen offset:768 nt
    buffer_load_dwordx3 v[40:42], v19, s[16:19], s25 offen offset:1536 nt
    buffer_load_dwordx3 v[44:46], v19, s[16:19], s25 offen offset:2304 nt
    buffer_load_dwordx3 v[48:50], v19, s[16:19], s25 offen offset:3072 nt
    buffer_load_dwordx3 v[52:54], v19, s[16:19], s25 offen offset:3840 nt
    buffer_load_dwordx3 v[56:58], v20, s[16:19], s25 offen offset:0 nt
    buffer_load_dwordx3 v[60:62], v20, s[16:19], s25 offen offset:768 nt
    buffer_load_dwordx3 v[96:98], v19, s[20:23], s25 offen offset:0 nt
    buffer_load_dwordx3 v[100:102], v19, s[20:23], s25 offen offset:768 nt
    buffer_load_dwordx3 v[104:106], v19, s[20:23], s25 offen offset:1536 nt
    buffer_load_dwordx3 v[108:110], v19, s[20:23], s25 offen offset:2304 nt
    buffer_load_dwordx3 v[112:114], v19, s[20:23], s25 offen offset:3072 nt
    buffer_load_dwordx3 v[116:118], v19, s[20:23], s25 offen offset:3840 nt
    buffer_load_dwordx3 v[120:122], v20, s[20:23], s25 offen offset:0 nt
    buffer_load_dwordx3 v[124:126], v20, s[20:23], s25 offen offset:768 nt
    s_add_u32 s25, s25, 6144
    s_mov_b32 s26, 8
attn_Aloop:
    buffer_load_dwordx3 v[64:66], v19, s[16:19], s25 offen offset:0 nt
    buffer_load_dwordx3 v[68:70], v19, s[16:19], s25 offen offset:768 nt
    buffer_load_dwordx3 v[72:74], v19, s[16:19], s25 offen offset:1536 nt
    buffer_load_dwordx3 v[76:78], v19, s[16:19], s25 offen offset:2304 nt
    buffer_load_dwordx3 v[80:82], v19, s[16:19], s25 offen offset:3072 nt
    buffer_load_dwordx3 v[84:86], v19, s[16:19], s25 offen offset:3840 nt
    buffer_load_dwordx3 v[88:90], v20, s[16:19], s25 offen offset:0 nt
    buffer_load_dwordx3 v[92:94], v20, s[16:19], s25 offen offset:768 nt
    buffer_load_dwordx3 v[128:130], v19, s[20:23], s25 offen offset:0 nt
    buffer_load_dwordx3 v[132:134], v19, s[20:23], s25 offen offset:768 nt
    buffer_load_dwordx3 v[136:138], v19, s[20:23], s25 offen offset:1536 nt
    buffer_load_dwordx3 v[140:142], v19, s[20:23], s25 offen offset:2304 nt
    buffer_load_dwordx3 v[144:146], v19, s[20:23], s25 offen offset:3072 nt
    buffer_load_dwordx3 v[148:150], v19, s[20:23], s25 offen offset:3840 nt
    buffer_load_dwordx3 v[152:154], v20, s[20:23], s25 offen offset:0 nt
    buffer_load_dwordx3 v[156:158], v20, s[20:23], s25 offen offset:768 nt
    s_add_u32 s25, s25, 6144
    s_waitcnt vmcnt(24)
    v_dot2_f32_bf16 v35, v32, v6, 0
    v_dot2_f32_bf16 v39, v36, v6, 0
    v_dot2_f32_bf16 v43, v40, v6, 0
    v_dot2_f32_bf16 v47, v44, v6, 0
    v_dot2_f32_bf16 v51, v48, v6, 0
    v_dot2_f32_bf16 v55, v52, v6, 0
    v_dot2_f32_bf16 v59, v56, v6, 0
    v_dot2_f32_bf16 v63, v60, v6, 0
    v_dot2_f32_bf16 v35, v33, v7, v35
    v_dot2_f32_bf16 v39, v37, v7, v39
    v_dot2_f32_bf16 v43, v41, v7, v43
    v_dot2_f32_bf16 v47, v45, v7, v47
    v_dot2_f32_bf16 v51, v49, v7, v51
    v_dot2_f32_bf16 v55, v53, v7, v55
    v_dot2_f32_bf16 v59, v57, v7, v59
    v_dot2_f32_bf16 v63, v61, v7, v63
    v_dot2_f32_bf16 v35, v34, v8, v35
    v_dot2_f32_bf16 v39, v38, v8, v39
    v_dot2_f32_bf16 v43, v42, v8, v43
    v_dot2_f32_bf16 v47, v46, v8, v47
    v_dot2_f32_bf16 v51, v50, v8, v51
    v_dot2_f32_bf16 v55, v54, v8, v55
    v_dot2_f32_bf16 v59, v58, v8, v59
    v_dot2_f32_bf16 v63, v62, v8, v63
    v_add_f32_dpp v35, v35, v35 quad_perm:[1,0,3,2] row_mask:0xf bank_mask:0xf
    v_add_f32_dpp v39, v39, v39 quad_perm:[1,0,3,2] row_mask:0xf bank_mask:0xf
    v_add_f32_dpp v43, v43, v43 quad_perm:[1,0,3,2] row_mask:0xf bank_mask:0xf
    v_add_f32_dpp v47, v47, v47 quad_perm:[1,0,3,2] row_mask:0xf bank_mask:0xf
    v_add_f32_dpp v51, v51, v51 quad_perm:[1,0,3,2] row_mask:0xf bank_mask:0xf
    v_add_f32_dpp v55, v55, v55 quad_perm:[1,0,3,2] row_mask:0xf bank_mask:0xf
    v_add_f32_dpp v59, v59, v59 quad_perm:[1,0,3,2] row_mask:0xf bank_mask:0xf
    v_add_f32_dpp v63, v63, v63 quad_perm:[1,0,3,2] row_mask:0xf bank_mask:0xf
    v_add_f32_dpp v35, v35, v35 quad_perm:[2,3,0,1] row_mask:0xf bank_mask:0xf
    v_add_f32_dpp v39, v39, v39 quad_perm:[2,3,0,1] row_mask:0xf bank_mask:0xf
    v_add_f32_dpp v43, v43, v43 quad_perm:[2,3,0,1] row_mask:0xf bank_mask:0xf
    v_add_f32_dpp v47, v47, v47 quad_perm:[2,3,0,1] row_mask:0xf bank_mask:0xf
    v_add_f32_dpp v51, v51, v51 quad_perm:[2,3,0,1] row_mask:0xf bank_mask:0xf
    v_add_f32_dpp v55, v55, v55 quad_perm:[2,3,0,1] row_mask:0xf bank_mask:0xf
    v_add_f32_dpp v59, v59, v59 quad_perm:[2,3,0,1] row_mask:0xf bank_mask:0xf
    v_add_f32_dpp v63, v63, v63 quad_perm:[2,3,0,1] row_mask:0xf bank_mask:0xf
    v_add_f32_dpp v35, v35, v35 row_half_mirror row_mask:0xf bank_mask:0xf
    v_add_f32_dpp v39, v39, v39 row_half_mirror row_mask:0xf bank_mask:0xf
    v_add_f32_dpp v43, v43, v43 row_half_mirror row_mask:0xf bank_mask:0xf
    v_add_f32_dpp v47, v47, v47 row_half_mirror row_mask:0xf bank_mask:0xf
    v_add_f32_dpp v51, v51, v51 row_half_mirror row_mask:0xf bank_mask:0xf
    v_add_f32_dpp v55, v55, v55 row_half_mirror row_mask:0xf bank_mask:0xf
    v_add_f32_dpp v59, v59, v59 row_half_mirror row_mask:0xf bank_mask:0xf
    v_add_f32_dpp v63, v63, v63 row_half_mirror row_mask:0xf bank_mask:0xf
    v_add_f32_dpp v35, v35, v35 row_mirror row_mask:0xf bank_mask:0xf
    v_add_f32_dpp v39, v39, v39 row_mirror row_mask:0xf bank_mask:0xf
    v_add_f32_dpp v43, v43, v43 row_mirror row_mask:0xf bank_mask:0xf
    v_add_f32_dpp v47, v47, v47 row_mirror row_mask:0xf bank_mask:0xf
    v_add_f32_dpp v51, v51, v51 row_mirror row_mask:0xf bank_mask:0xf
    v_add_f32_dpp v55, v55, v55 row_mirror row_mask:0xf bank_mask:0xf
    v_add_f32_dpp v59, v59, v59 row_mirror row_mask:0xf bank_mask:0xf
    v_add_f32_dpp v63, v63, v63 row_mirror row_mask:0xf bank_mask:0xf
    v_mov_b32 v99, v35
    v_mov_b32 v103, v39
    v_mov_b32 v107, v43
    v_mov_b32 v111, v47
    v_mov_b32 v115, v51
    v_mov_b32 v119, v55
    v_mov_b32 v123, v59
    v_mov_b32 v127, v63
    s_nop 1
    v_permlane16_swap_b32 v99, v35
    v_permlane16_swap_b32 v103, v39
    v_permlane16_swap_b32 v107, v43
    v_permlane16_swap_b32 v111, v47
    v_permlane16_swap_b32 v115, v51
    v_permlane16_swap_b32 v119, v55
    v_permlane16_swap_b32 v123, v59
    v_permlane16_swap_b32 v127, v63
    s_nop 1
    v_add_f32 v35, v35, v99
    v_add_f32 v39, v39, v103
    v_add_f32 v43, v43, v107
    v_add_f32 v47, v47, v111
    v_add_f32 v51, v51, v115
    v_add_f32 v55, v55, v119
    v_add_f32 v59, v59, v123
    v_add_f32 v63, v63, v127
    v_mul_f32 v35, s27, v35
    v_mul_f32 v39, s27, v39
    v_mul_f32 v43, s27, v43
    v_mul_f32 v47, s27, v47
    v_mul_f32 v51, s27, v51
    v_mul_f32 v55, s27, v55
    v_mul_f32 v59, s27, v59
    v_mul_f32 v63, s27, v63
    v_max3_f32 v160, v35, v39, v43
    v_max3_f32 v161, v47, v51, v55
    v_max3_f32 v162, v59, v63, v9
    v_max3_f32 v160, v160, v161, v162
    v_sub_f32 v161, v9, v160
    v_exp_f32 v161, v161
    v_mov_b32 v9, v160

    v_sub_f32 v35, v35, v160
    v_sub_f32 v39, v39, v160
    v_sub_f32 v43, v43, v160
    v_sub_f32 v47, v47, v160
    v_sub_f32 v51, v51, v160
    v_sub_f32 v55, v55, v160
    v_sub_f32 v59, v59, v160
    v_sub_f32 v63, v63, v160
    v_exp_f32 v35, v35
    v_exp_f32 v39, v39
    v_exp_f32 v43, v43
    v_exp_f32 v47, v47
    v_exp_f32 v51, v51
    v_exp_f32 v55, v55
    v_exp_f32 v59, v59
    v_exp_f32 v63, v63
    v_mul_f32 v10, v10, v161
    v_mul_f32 v12, v12, v161
    v_mul_f32 v13, v13, v161
    v_mul_f32 v14, v14, v161
    v_mul_f32 v15, v15, v161
    v_mul_f32 v16, v16, v161
    v_mul_f32 v17, v17, v161
    v_cvt_pk_bf16_f32 v67, v35, 0
    v_cvt_pk_bf16_f32 v131, 0, v35
    v_cvt_pk_bf16_f32 v71, v39, 0
    v_cvt_pk_bf16_f32 v135, 0, v39
    v_cvt_pk_bf16_f32 v75, v43, 0
    v_cvt_pk_bf16_f32 v139, 0, v43
    v_cvt_pk_bf16_f32 v79, v47, 0
    v_cvt_pk_bf16_f32 v143, 0, v47
    v_cvt_pk_bf16_f32 v83, v51, 0
    v_cvt_pk_bf16_f32 v147, 0, v51
    v_cvt_pk_bf16_f32 v87, v55, 0
    v_cvt_pk_bf16_f32 v151, 0, v55
    v_cvt_pk_bf16_f32 v91, v59, 0
    v_cvt_pk_bf16_f32 v155, 0, v59
    v_cvt_pk_bf16_f32 v95, v63, 0
    v_cvt_pk_bf16_f32 v159, 0, v63
    v_add_f32 v162, v35, v39
    v_add_f32 v163, v43, v47
    v_add_f32 v164, v51, v55
    v_add_f32 v165, v59, v63
    v_add_f32 v162, v162, v163
    v_add_f32 v164, v164, v165
    v_add_f32 v162, v162, v164
    v_add_f32 v10, v10, v162
    s_waitcnt vmcnt(16)

    v_dot2_f32_bf16 v12, v96, v67, v12
    v_dot2_f32_bf16 v13, v96, v131, v13
    v_dot2_f32_bf16 v14, v97, v67, v14
    v_dot2_f32_bf16 v15, v97, v131, v15
    v_dot2_f32_bf16 v16, v98, v67, v16
    v_dot2_f32_bf16 v17, v98, v131, v17
    v_dot2_f32_bf16 v12, v100, v71, v12
    v_dot2_f32_bf16 v13, v100, v135, v13
    v_dot2_f32_bf16 v14, v101, v71, v14
    v_dot2_f32_bf16 v15, v101, v135, v15
    v_dot2_f32_bf16 v16, v102, v71, v16
    v_dot2_f32_bf16 v17, v102, v135, v17
    v_dot2_f32_bf16 v12, v104, v75, v12
    v_dot2_f32_bf16 v13, v104, v139, v13
    v_dot2_f32_bf16 v14, v105, v75, v14
    v_dot2_f32_bf16 v15, v105, v139, v15
    v_dot2_f32_bf16 v16, v106, v75, v16
    v_dot2_f32_bf16 v17, v106, v139, v17
    v_dot2_f32_bf16 v12, v108, v79, v12
    v_dot2_f32_bf16 v13, v108, v143, v13
    v_dot2_f32_bf16 v14, v109, v79, v14
    v_dot2_f32_bf16 v15, v109, v143, v15
    v_dot2_f32_bf16 v16, v110, v79, v16
    v_dot2_f32_bf16 v17, v110, v143, v17
    v_dot2_f32_bf16 v12, v112, v83, v12
    v_dot2_f32_bf16 v13, v112, v147, v13
    v_dot2_f32_bf16 v14, v113, v83, v14
    v_dot2_f32_bf16 v15, v113, v147, v15
    v_dot2_f32_bf16 v16, v114, v83, v16
    v_dot2_f32_bf16 v17, v114, v147, v17
    v_dot2_f32_bf16 v12, v116, v87, v12
    v_dot2_f32_bf16 v13, v116, v151, v13
    v_dot2_f32_bf16 v14, v117, v87, v14
    v_dot2_f32_bf16 v15, v117, v151, v15
    v_dot2_f32_bf16 v16, v118, v87, v16
    v_dot2_f32_bf16 v17, v118, v151, v17
    v_dot2_f32_bf16 v12, v120, v91, v12
    v_dot2_f32_bf16 v13, v120, v155, v13
    v_dot2_f32_bf16 v14, v121, v91, v14
    v_dot2_f32_bf16 v15, v121, v155, v15
    v_dot2_f32_bf16 v16, v122, v91, v16
    v_dot2_f32_bf16 v17, v122, v155, v17
    v_dot2_f32_bf16 v12, v124, v95, v12
    v_dot2_f32_bf16 v13, v124, v159, v13
    v_dot2_f32_bf16 v14, v125, v95, v14
    v_dot2_f32_bf16 v15, v125, v159, v15
    v_dot2_f32_bf16 v16, v126, v95, v16
    v_dot2_f32_bf16 v17, v126, v159, v17
    s_sub_u32 s26, s26, 1
    s_cmp_eq_u32 s26, 0
    s_cselect_b32 s25, 0x80000000, s25
    buffer_load_dwordx3 v[32:34], v19, s[16:19], s25 offen offset:0 nt
    buffer_load_dwordx3 v[36:38], v19, s[16:19], s25 offen offset:768 nt
    buffer_load_dwordx3 v[40:42], v19, s[16:19], s25 offen offset:1536 nt
    buffer_load_dwordx3 v[44:46], v19, s[16:19], s25 offen offset:2304 nt
    buffer_load_dwordx3 v[48:50], v19, s[16:19], s25 offen offset:3072 nt
    buffer_load_dwordx3 v[52:54], v19, s[16:19], s25 offen offset:3840 nt
    buffer_load_dwordx3 v[56:58], v20, s[16:19], s25 offen offset:0 nt
    buffer_load_dwordx3 v[60:62], v20, s[16:19], s25 offen offset:768 nt
    buffer_load_dwordx3 v[96:98], v19, s[20:23], s25 offen offset:0 nt
    buffer_load_dwordx3 v[100:102], v19, s[20:23], s25 offen offset:768 nt
    buffer_load_dwordx3 v[104:106], v19, s[20:23], s25 offen offset:1536 nt
    buffer_load_dwordx3 v[108:110], v19, s[20:23], s25 offen offset:2304 nt
    buffer_load_dwordx3 v[112:114], v19, s[20:23], s25 offen offset:3072 nt
    buffer_load_dwordx3 v[116:118], v19, s[20:23], s25 offen offset:3840 nt
    buffer_load_dwordx3 v[120:122], v20, s[20:23], s25 offen offset:0 nt
    buffer_load_dwordx3 v[124:126], v20, s[20:23], s25 offen offset:768 nt
    s_add_u32 s25, s25, 6144
    s_waitcnt vmcnt(24)
    v_dot2_f32_bf16 v67, v64, v6, 0
    v_dot2_f32_bf16 v71, v68, v6, 0
    v_dot2_f32_bf16 v75, v72, v6, 0
    v_dot2_f32_bf16 v79, v76, v6, 0
    v_dot2_f32_bf16 v83, v80, v6, 0
    v_dot2_f32_bf16 v87, v84, v6, 0
    v_dot2_f32_bf16 v91, v88, v6, 0
    v_dot2_f32_bf16 v95, v92, v6, 0
    v_dot2_f32_bf16 v67, v65, v7, v67
    v_dot2_f32_bf16 v71, v69, v7, v71
    v_dot2_f32_bf16 v75, v73, v7, v75
    v_dot2_f32_bf16 v79, v77, v7, v79
    v_dot2_f32_bf16 v83, v81, v7, v83
    v_dot2_f32_bf16 v87, v85, v7, v87
    v_dot2_f32_bf16 v91, v89, v7, v91
    v_dot2_f32_bf16 v95, v93, v7, v95
    v_dot2_f32_bf16 v67, v66, v8, v67
    v_dot2_f32_bf16 v71, v70, v8, v71
    v_dot2_f32_bf16 v75, v74, v8, v75
    v_dot2_f32_bf16 v79, v78, v8, v79
    v_dot2_f32_bf16 v83, v82, v8, v83
    v_dot2_f32_bf16 v87, v86, v8, v87
    v_dot2_f32_bf16 v91, v90, v8, v91
    v_dot2_f32_bf16 v95, v94, v8, v95
    v_add_f32_dpp v67, v67, v67 quad_perm:[1,0,3,2] row_mask:0xf bank_mask:0xf
    v_add_f32_dpp v71, v71, v71 quad_perm:[1,0,3,2] row_mask:0xf bank_mask:0xf
    v_add_f32_dpp v75, v75, v75 quad_perm:[1,0,3,2] row_mask:0xf bank_mask:0xf
    v_add_f32_dpp v79, v79, v79 quad_perm:[1,0,3,2] row_mask:0xf bank_mask:0xf
    v_add_f32_dpp v83, v83, v83 quad_perm:[1,0,3,2] row_mask:0xf bank_mask:0xf
    v_add_f32_dpp v87, v87, v87 quad_perm:[1,0,3,2] row_mask:0xf bank_mask:0xf
    v_add_f32_dpp v91, v91, v91 quad_perm:[1,0,3,2] row_mask:0xf bank_mask:0xf
    v_add_f32_dpp v95, v95, v95 quad_perm:[1,0,3,2] row_mask:0xf bank_mask:0xf
    v_add_f32_dpp v67, v67, v67 quad_perm:[2,3,0,1] row_mask:0xf bank_mask:0xf
    v_add_f32_dpp v71, v71, v71 quad_perm:[2,3,0,1] row_mask:0xf bank_mask:0xf
    v_add_f32_dpp v75, v75, v75 quad_perm:[2,3,0,1] row_mask:0xf bank_mask:0xf
    v_add_f32_dpp v79, v79, v79 quad_perm:[2,3,0,1] row_mask:0xf bank_mask:0xf
    v_add_f32_dpp v83, v83, v83 quad_perm:[2,3,0,1] row_mask:0xf bank_mask:0xf
    v_add_f32_dpp v87, v87, v87 quad_perm:[2,3,0,1] row_mask:0xf bank_mask:0xf
    v_add_f32_dpp v91, v91, v91 quad_perm:[2,3,0,1] row_mask:0xf bank_mask:0xf
    v_add_f32_dpp v95, v95, v95 quad_perm:[2,3,0,1] row_mask:0xf bank_mask:0xf
    v_add_f32_dpp v67, v67, v67 row_half_mirror row_mask:0xf bank_mask:0xf
    v_add_f32_dpp v71, v71, v71 row_half_mirror row_mask:0xf bank_mask:0xf
    v_add_f32_dpp v75, v75, v75 row_half_mirror row_mask:0xf bank_mask:0xf
    v_add_f32_dpp v79, v79, v79 row_half_mirror row_mask:0xf bank_mask:0xf
    v_add_f32_dpp v83, v83, v83 row_half_mirror row_mask:0xf bank_mask:0xf
    v_add_f32_dpp v87, v87, v87 row_half_mirror row_mask:0xf bank_mask:0xf
    v_add_f32_dpp v91, v91, v91 row_half_mirror row_mask:0xf bank_mask:0xf
    v_add_f32_dpp v95, v95, v95 row_half_mirror row_mask:0xf bank_mask:0xf
    v_add_f32_dpp v67, v67, v67 row_mirror row_mask:0xf bank_mask:0xf
    v_add_f32_dpp v71, v71, v71 row_mirror row_mask:0xf bank_mask:0xf
    v_add_f32_dpp v75, v75, v75 row_mirror row_mask:0xf bank_mask:0xf
    v_add_f32_dpp v79, v79, v79 row_mirror row_mask:0xf bank_mask:0xf
    v_add_f32_dpp v83, v83, v83 row_mirror row_mask:0xf bank_mask:0xf
    v_add_f32_dpp v87, v87, v87 row_mirror row_mask:0xf bank_mask:0xf
    v_add_f32_dpp v91, v91, v91 row_mirror row_mask:0xf bank_mask:0xf
    v_add_f32_dpp v95, v95, v95 row_mirror row_mask:0xf bank_mask:0xf
    v_mov_b32 v131, v67
    v_mov_b32 v135, v71
    v_mov_b32 v139, v75
    v_mov_b32 v143, v79
    v_mov_b32 v147, v83
    v_mov_b32 v151, v87
    v_mov_b32 v155, v91
    v_mov_b32 v159, v95
    s_nop 1
    v_permlane16_swap_b32 v131, v67
    v_permlane16_swap_b32 v135, v71
    v_permlane16_swap_b32 v139, v75
    v_permlane16_swap_b32 v143, v79
    v_permlane16_swap_b32 v147, v83
    v_permlane16_swap_b32 v151, v87
    v_permlane16_swap_b32 v155, v91
    v_permlane16_swap_b32 v159, v95
    s_nop 1
    v_add_f32 v67, v67, v131
    v_add_f32 v71, v71, v135
    v_add_f32 v75, v75, v139
    v_add_f32 v79, v79, v143
    v_add_f32 v83, v83, v147
    v_add_f32 v87, v87, v151
    v_add_f32 v91, v91, v155
    v_add_f32 v95, v95, v159
    v_mul_f32 v67, s27, v67
    v_mul_f32 v71, s27, v71
    v_mul_f32 v75, s27, v75
    v_mul_f32 v79, s27, v79
    v_mul_f32 v83, s27, v83
    v_mul_f32 v87, s27, v87
    v_mul_f32 v91, s27, v91
    v_mul_f32 v95, s27, v95
    v_max3_f32 v160, v67, v71, v75
    v_max3_f32 v161, v79, v83, v87
    v_max3_f32 v162, v91, v95, v9
    v_max3_f32 v160, v160, v161, v162
    v_sub_f32 v161, v9, v160
    v_exp_f32 v161, v161
    v_mov_b32 v9, v160

    v_sub_f32 v67, v67, v160
    v_sub_f32 v71, v71, v160
    v_sub_f32 v75, v75, v160
    v_sub_f32 v79, v79, v160
    v_sub_f32 v83, v83, v160
    v_sub_f32 v87, v87, v160
    v_sub_f32 v91, v91, v160
    v_sub_f32 v95, v95, v160
    v_exp_f32 v67, v67
    v_exp_f32 v71, v71
    v_exp_f32 v75, v75
    v_exp_f32 v79, v79
    v_exp_f32 v83, v83
    v_exp_f32 v87, v87
    v_exp_f32 v91, v91
    v_exp_f32 v95, v95
    v_mul_f32 v10, v10, v161
    v_mul_f32 v12, v12, v161
    v_mul_f32 v13, v13, v161
    v_mul_f32 v14, v14, v161
    v_mul_f32 v15, v15, v161
    v_mul_f32 v16, v16, v161
    v_mul_f32 v17, v17, v161
    v_cvt_pk_bf16_f32 v35, v67, 0
    v_cvt_pk_bf16_f32 v99, 0, v67
    v_cvt_pk_bf16_f32 v39, v71, 0
    v_cvt_pk_bf16_f32 v103, 0, v71
    v_cvt_pk_bf16_f32 v43, v75, 0
    v_cvt_pk_bf16_f32 v107, 0, v75
    v_cvt_pk_bf16_f32 v47, v79, 0
    v_cvt_pk_bf16_f32 v111, 0, v79
    v_cvt_pk_bf16_f32 v51, v83, 0
    v_cvt_pk_bf16_f32 v115, 0, v83
    v_cvt_pk_bf16_f32 v55, v87, 0
    v_cvt_pk_bf16_f32 v119, 0, v87
    v_cvt_pk_bf16_f32 v59, v91, 0
    v_cvt_pk_bf16_f32 v123, 0, v91
    v_cvt_pk_bf16_f32 v63, v95, 0
    v_cvt_pk_bf16_f32 v127, 0, v95
    v_add_f32 v162, v67, v71
    v_add_f32 v163, v75, v79
    v_add_f32 v164, v83, v87
    v_add_f32 v165, v91, v95
    v_add_f32 v162, v162, v163
    v_add_f32 v164, v164, v165
    v_add_f32 v162, v162, v164
    v_add_f32 v10, v10, v162
    s_waitcnt vmcnt(16)

    v_dot2_f32_bf16 v12, v128, v35, v12
    v_dot2_f32_bf16 v13, v128, v99, v13
    v_dot2_f32_bf16 v14, v129, v35, v14
    v_dot2_f32_bf16 v15, v129, v99, v15
    v_dot2_f32_bf16 v16, v130, v35, v16
    v_dot2_f32_bf16 v17, v130, v99, v17
    v_dot2_f32_bf16 v12, v132, v39, v12
    v_dot2_f32_bf16 v13, v132, v103, v13
    v_dot2_f32_bf16 v14, v133, v39, v14
    v_dot2_f32_bf16 v15, v133, v103, v15
    v_dot2_f32_bf16 v16, v134, v39, v16
    v_dot2_f32_bf16 v17, v134, v103, v17
    v_dot2_f32_bf16 v12, v136, v43, v12
    v_dot2_f32_bf16 v13, v136, v107, v13
    v_dot2_f32_bf16 v14, v137, v43, v14
    v_dot2_f32_bf16 v15, v137, v107, v15
    v_dot2_f32_bf16 v16, v138, v43, v16
    v_dot2_f32_bf16 v17, v138, v107, v17
    v_dot2_f32_bf16 v12, v140, v47, v12
    v_dot2_f32_bf16 v13, v140, v111, v13
    v_dot2_f32_bf16 v14, v141, v47, v14
    v_dot2_f32_bf16 v15, v141, v111, v15
    v_dot2_f32_bf16 v16, v142, v47, v16
    v_dot2_f32_bf16 v17, v142, v111, v17
    v_dot2_f32_bf16 v12, v144, v51, v12
    v_dot2_f32_bf16 v13, v144, v115, v13
    v_dot2_f32_bf16 v14, v145, v51, v14
    v_dot2_f32_bf16 v15, v145, v115, v15
    v_dot2_f32_bf16 v16, v146, v51, v16
    v_dot2_f32_bf16 v17, v146, v115, v17
    v_dot2_f32_bf16 v12, v148, v55, v12
    v_dot2_f32_bf16 v13, v148, v119, v13
    v_dot2_f32_bf16 v14, v149, v55, v14
    v_dot2_f32_bf16 v15, v149, v119, v15
    v_dot2_f32_bf16 v16, v150, v55, v16
    v_dot2_f32_bf16 v17, v150, v119, v17
    v_dot2_f32_bf16 v12, v152, v59, v12
    v_dot2_f32_bf16 v13, v152, v123, v13
    v_dot2_f32_bf16 v14, v153, v59, v14
    v_dot2_f32_bf16 v15, v153, v123, v15
    v_dot2_f32_bf16 v16, v154, v59, v16
    v_dot2_f32_bf16 v17, v154, v123, v17
    v_dot2_f32_bf16 v12, v156, v63, v12
    v_dot2_f32_bf16 v13, v156, v127, v13
    v_dot2_f32_bf16 v14, v157, v63, v14
    v_dot2_f32_bf16 v15, v157, v127, v15
    v_dot2_f32_bf16 v16, v158, v63, v16
    v_dot2_f32_bf16 v17, v158, v127, v17
    s_cmp_lg_u32 s26, 0
    s_cbranch_scc1 attn_Aloop
    s_waitcnt vmcnt(0)
    v_lshlrev_b32 v21, 1, v1
    v_add_u32 v21, v21, v3
    v_lshlrev_b32 v22, 2, v21
    ds_write_b32 v22, v9
    ds_write_b32 v22, v10 offset:32
    v_mul_u32_u24 v23, 768, v21
    v_lshlrev_b32 v24, 1, v5
    v_add_u32 v23, v23, v24
    ds_write_b64 v23, v[12:13] offset:64
    ds_write_b64 v23, v[14:15] offset:72
    ds_write_b64 v23, v[16:17] offset:80
    s_waitcnt lgkmcnt(0)
    s_barrier
    v_cmp_gt_u32 vcc, 192, v0
    s_and_saveexec_b64 s[28:29], vcc
    s_cbranch_execz attn_exit
    v_mov_b32 v22, 0
    ds_read_b128 v[32:35], v22
    ds_read_b128 v[36:39], v22 offset:16
    ds_read_b128 v[40:43], v22 offset:32
    ds_read_b128 v[44:47], v22 offset:48
    v_lshlrev_b32 v23, 2, v0

    ds_read_b32 v48, v23 offset:64
    ds_read_b32 v49, v23 offset:832
    ds_read_b32 v50, v23 offset:1600
    ds_read_b32 v51, v23 offset:2368
    ds_read_b32 v52, v23 offset:3136
    ds_read_b32 v53, v23 offset:3904
    ds_read_b32 v54, v23 offset:4672
    ds_read_b32 v55, v23 offset:5440
    s_waitcnt lgkmcnt(0)
    v_max3_f32 v24, v32, v33, v34
    v_max3_f32 v25, v35, v36, v37
    v_max3_f32 v24, v24, v38, v39
    v_max_f32 v24, v24, v25

    v_sub_f32 v32, v32, v24
    v_sub_f32 v33, v33, v24
    v_sub_f32 v34, v34, v24
    v_sub_f32 v35, v35, v24
    v_sub_f32 v36, v36, v24
    v_sub_f32 v37, v37, v24
    v_sub_f32 v38, v38, v24
    v_sub_f32 v39, v39, v24
    v_exp_f32 v32, v32
    v_exp_f32 v33, v33
    v_exp_f32 v34, v34
    v_exp_f32 v35, v35
    v_exp_f32 v36, v36
    v_exp_f32 v37, v37
    v_exp_f32 v38, v38
    v_exp_f32 v39, v39
    v_mov_b32 v25, 0
    v_mov_b32 v26, 0
    v_fmac_f32 v25, v32, v40
    v_fmac_f32 v26, v32, v48
    v_fmac_f32 v25, v33, v41
    v_fmac_f32 v26, v33, v49
    v_fmac_f32 v25, v34, v42
    v_fmac_f32 v26, v34, v50
    v_fmac_f32 v25, v35, v43
    v_fmac_f32 v26, v35, v51
    v_fmac_f32 v25, v36, v44
    v_fmac_f32 v26, v36, v52
    v_fmac_f32 v25, v37, v45
    v_fmac_f32 v26, v37, v53
    v_fmac_f32 v25, v38, v46
    v_fmac_f32 v26, v38, v54
    v_fmac_f32 v25, v39, v47
    v_fmac_f32 v26, v39, v55
    s_lshl_b32 s24, s6, 3
    s_add_u32 s24, s24, s7
    s_lshl_b32 s24, s24, 10
    s_add_u32 s24, s24, 262144
    buffer_store_dword v26, v23, s[8:11], s24 offen
    v_cmp_eq_u32 vcc, 0, v0
    s_and_saveexec_b64 s[28:29], vcc
    s_cbranch_execz attn_exit
    buffer_store_dwordx2 v[24:25], v23, s[8:11], s24 offen offset:768
    s_branch attn_exit

attn_B:
    s_load_dwordx2 s[12:13], s[0:1], 48
    s_lshr_b32 s6, s2, 1
    s_and_b32 s7, s2, 1
    s_waitcnt lgkmcnt(0)

    s_mov_b32 s8, s4
    s_and_b32 s9, s5, 0xffff
    s_mov_b32 s10, 8388608
    s_mov_b32 s11, 0x00020000

    s_mov_b32 s16, s12
    s_and_b32 s17, s13, 0xffff
    s_mov_b32 s18, 12582912
    s_mov_b32 s19, 0x00020000

    v_lshlrev_b32 v5, 4, v0
    s_movk_i32 s20, 683

    v_add_u32 v9, 0, v0
    v_mul_lo_u32 v10, v9, s20
    v_lshrrev_b32 v10, 16, v10
    v_mul_u32_u24 v11, 96, v10
    v_sub_u32 v11, v9, v11
    v_lshlrev_b32 v11, 4, v11
    v_mul_u32_u24 v10, 1552, v10
    v_add_u32 v6, v10, v11

    v_add_u32 v9, 256, v0
    v_mul_lo_u32 v10, v9, s20
    v_lshrrev_b32 v10, 16, v10
    v_mul_u32_u24 v11, 96, v10
    v_sub_u32 v11, v9, v11
    v_lshlrev_b32 v11, 4, v11
    v_mul_u32_u24 v10, 1552, v10
    v_add_u32 v7, v10, v11

    v_add_u32 v9, 512, v0
    v_mul_lo_u32 v10, v9, s20
    v_lshrrev_b32 v10, 16, v10
    v_mul_u32_u24 v11, 96, v10
    v_sub_u32 v11, v9, v11
    v_lshlrev_b32 v11, 4, v11
    v_mul_u32_u24 v10, 1552, v10
    v_add_u32 v8, v10, v11

    s_mul_i32 s21, s3, 384
    v_mul_u32_u24 v9, 1552, v4
    v_lshlrev_b32 v13, 4, v3
    v_add_u32 v9, v9, v13
    v_add_u32 v9, s21, v9
    v_mul_u32_u24 v10, 1536, v4
    v_add_u32 v10, v10, v13
    v_add_u32 v10, s21, v10
    v_and_b32 v13, 15, v2
    v_lshrrev_b32 v14, 2, v13
    v_lshlrev_b32 v15, 2, v3
    v_add_u32 v14, v14, v15
    v_mul_u32_u24 v11, 1552, v14
    v_and_b32 v13, 3, v13
    v_lshlrev_b32 v13, 3, v13
    v_add_u32 v11, v11, v13
    v_and_b32 v13, 16, v2
    v_lshlrev_b32 v13, 1, v13
    v_add_u32 v11, v11, v13
    s_mul_i32 s22, s7, 768
    s_mul_i32 s23, s3, 192
    s_add_u32 s22, s22, s23
    v_add_u32 v11, s22, v11
    v_lshlrev_b32 v12, 6, v2
    v_add_u32 v12, 49664, v12
    v_mov_b32 v14, 0xf149f2ca
    v_mov_b32 v15, 0
    s_mov_b32 s26, 196608
    s_mul_i32 s24, s6, 196608
    s_mov_b32 s27, 1037384597

    v_mov_b32 v16, 0
    v_mov_b32 v17, 0
    v_mov_b32 v18, 0
    v_mov_b32 v19, 0
    v_mov_b32 v20, 0
    v_mov_b32 v21, 0
    v_mov_b32 v22, 0
    v_mov_b32 v23, 0
    v_mov_b32 v24, 0
    v_mov_b32 v25, 0
    v_mov_b32 v26, 0
    v_mov_b32 v27, 0
    v_mov_b32 v28, 0
    v_mov_b32 v29, 0
    v_mov_b32 v30, 0
    v_mov_b32 v31, 0
    v_mov_b32 v32, 0
    v_mov_b32 v33, 0
    v_mov_b32 v34, 0
    v_mov_b32 v35, 0
    v_mov_b32 v36, 0
    v_mov_b32 v37, 0
    v_mov_b32 v38, 0
    v_mov_b32 v39, 0
    v_mov_b32 v40, 0
    v_mov_b32 v41, 0
    v_mov_b32 v42, 0
    v_mov_b32 v43, 0
    v_mov_b32 v44, 0
    v_mov_b32 v45, 0
    v_mov_b32 v46, 0
    v_mov_b32 v47, 0
    v_mov_b32 v48, 0
    v_mov_b32 v49, 0
    v_mov_b32 v50, 0
    v_mov_b32 v51, 0
    v_mov_b32 v52, 0
    v_mov_b32 v53, 0
    v_mov_b32 v54, 0
    v_mov_b32 v55, 0
    v_mov_b32 v56, 0
    v_mov_b32 v57, 0
    v_mov_b32 v58, 0
    v_mov_b32 v59, 0
    v_mov_b32 v60, 0
    v_mov_b32 v61, 0
    v_mov_b32 v62, 0
    v_mov_b32 v63, 0
    buffer_load_dwordx4 v[160:163], v10, s[8:11], s26 offen offset:0
    buffer_load_dwordx4 v[164:167], v10, s[8:11], s26 offen offset:32
    buffer_load_dwordx4 v[168:171], v10, s[8:11], s26 offen offset:64
    buffer_load_dwordx4 v[172:175], v10, s[8:11], s26 offen offset:96
    buffer_load_dwordx4 v[176:179], v10, s[8:11], s26 offen offset:128
    buffer_load_dwordx4 v[180:183], v10, s[8:11], s26 offen offset:160
    buffer_load_dwordx4 v[184:187], v10, s[8:11], s26 offen offset:192
    buffer_load_dwordx4 v[188:191], v10, s[8:11], s26 offen offset:224
    buffer_load_dwordx4 v[192:195], v10, s[8:11], s26 offen offset:256
    buffer_load_dwordx4 v[196:199], v10, s[8:11], s26 offen offset:288
    buffer_load_dwordx4 v[200:203], v10, s[8:11], s26 offen offset:320
    buffer_load_dwordx4 v[204:207], v10, s[8:11], s26 offen offset:352
    buffer_load_dwordx4 v[64:67], v5, s[16:19], s24 offen nt
    s_add_u32 s24, s24, 4096
    buffer_load_dwordx4 v[68:71], v5, s[16:19], s24 offen nt
    s_add_u32 s24, s24, 4096
    buffer_load_dwordx4 v[72:75], v5, s[16:19], s24 offen nt
    s_add_u32 s24, s24, 4096
    buffer_load_dwordx4 v[76:79], v5, s[16:19], s24 offen nt
    s_add_u32 s24, s24, 4096
    buffer_load_dwordx4 v[80:83], v5, s[16:19], s24 offen nt
    s_add_u32 s24, s24, 4096
    buffer_load_dwordx4 v[84:87], v5, s[16:19], s24 offen nt
    s_add_u32 s24, s24, 4096
    buffer_load_dwordx4 v[88:91], v5, s[16:19], s24 offen nt
    s_add_u32 s24, s24, 4096
    buffer_load_dwordx4 v[92:95], v5, s[16:19], s24 offen nt
    s_add_u32 s24, s24, 4096
    buffer_load_dwordx4 v[96:99], v5, s[16:19], s24 offen nt
    s_add_u32 s24, s24, 4096
    buffer_load_dwordx4 v[100:103], v5, s[16:19], s24 offen nt
    s_add_u32 s24, s24, 4096
    buffer_load_dwordx4 v[104:107], v5, s[16:19], s24 offen nt
    s_add_u32 s24, s24, 4096
    buffer_load_dwordx4 v[108:111], v5, s[16:19], s24 offen nt
    s_add_u32 s24, s24, 4096
    s_mov_b32 s30, 4
attn_Bloop:
    s_waitcnt vmcnt(11)
    ds_write_b128 v6, v[64:67] offset:0
    s_waitcnt vmcnt(10)
    ds_write_b128 v7, v[68:71] offset:0
    s_waitcnt vmcnt(9)
    ds_write_b128 v8, v[72:75] offset:0
    s_waitcnt vmcnt(8)
    ds_write_b128 v6, v[76:79] offset:12416
    s_waitcnt vmcnt(7)
    ds_write_b128 v7, v[80:83] offset:12416
    s_waitcnt vmcnt(6)
    ds_write_b128 v8, v[84:87] offset:12416
    s_waitcnt vmcnt(5)
    ds_write_b128 v6, v[88:91] offset:24832
    s_waitcnt vmcnt(4)
    ds_write_b128 v7, v[92:95] offset:24832
    s_waitcnt vmcnt(3)
    ds_write_b128 v8, v[96:99] offset:24832
    s_waitcnt vmcnt(2)
    ds_write_b128 v6, v[100:103] offset:37248
    s_waitcnt vmcnt(1)
    ds_write_b128 v7, v[104:107] offset:37248
    s_waitcnt vmcnt(0)
    ds_write_b128 v8, v[108:111] offset:37248
    s_cmp_eq_u32 s30, 1
    s_cselect_b32 s24, 0x80000000, s24
    s_waitcnt lgkmcnt(0)
    buffer_load_dwordx4 v[64:67], v5, s[16:19], s24 offen nt
    s_add_u32 s24, s24, 4096
    buffer_load_dwordx4 v[68:71], v5, s[16:19], s24 offen nt
    s_add_u32 s24, s24, 4096
    buffer_load_dwordx4 v[72:75], v5, s[16:19], s24 offen nt
    s_add_u32 s24, s24, 4096
    buffer_load_dwordx4 v[76:79], v5, s[16:19], s24 offen nt
    s_add_u32 s24, s24, 4096
    buffer_load_dwordx4 v[80:83], v5, s[16:19], s24 offen nt
    s_add_u32 s24, s24, 4096
    buffer_load_dwordx4 v[84:87], v5, s[16:19], s24 offen nt
    s_add_u32 s24, s24, 4096
    buffer_load_dwordx4 v[88:91], v5, s[16:19], s24 offen nt
    s_add_u32 s24, s24, 4096
    buffer_load_dwordx4 v[92:95], v5, s[16:19], s24 offen nt
    s_add_u32 s24, s24, 4096
    buffer_load_dwordx4 v[96:99], v5, s[16:19], s24 offen nt
    s_add_u32 s24, s24, 4096
    buffer_load_dwordx4 v[100:103], v5, s[16:19], s24 offen nt
    s_add_u32 s24, s24, 4096
    buffer_load_dwordx4 v[104:107], v5, s[16:19], s24 offen nt
    s_add_u32 s24, s24, 4096
    buffer_load_dwordx4 v[108:111], v5, s[16:19], s24 offen nt
    s_add_u32 s24, s24, 4096
    s_waitcnt lgkmcnt(0)
    s_barrier
    v_mov_b32 v112, 0
    v_mov_b32 v113, 0
    v_mov_b32 v114, 0
    v_mov_b32 v115, 0
    v_mov_b32 v116, 0
    v_mov_b32 v117, 0
    v_mov_b32 v118, 0
    v_mov_b32 v119, 0
    v_mov_b32 v120, 0
    v_mov_b32 v121, 0
    v_mov_b32 v122, 0
    v_mov_b32 v123, 0
    v_mov_b32 v124, 0
    v_mov_b32 v125, 0
    v_mov_b32 v126, 0
    v_mov_b32 v127, 0
    ds_read_b128 v[136:139], v9 offset:0
    s_waitcnt lgkmcnt(0)
    v_mfma_f32_32x32x16_bf16 v[112:127], v[136:139], v[160:163], v[112:127]
    ds_read_b128 v[140:143], v9 offset:32
    s_waitcnt lgkmcnt(0)
    v_mfma_f32_32x32x16_bf16 v[112:127], v[140:143], v[164:167], v[112:127]
    ds_read_b128 v[136:139], v9 offset:64
    s_waitcnt lgkmcnt(0)
    v_mfma_f32_32x32x16_bf16 v[112:127], v[136:139], v[168:171], v[112:127]
    ds_read_b128 v[140:143], v9 offset:96
    s_waitcnt lgkmcnt(0)
    v_mfma_f32_32x32x16_bf16 v[112:127], v[140:143], v[172:175], v[112:127]
    ds_read_b128 v[136:139], v9 offset:128
    s_waitcnt lgkmcnt(0)
    v_mfma_f32_32x32x16_bf16 v[112:127], v[136:139], v[176:179], v[112:127]
    ds_read_b128 v[140:143], v9 offset:160
    s_waitcnt lgkmcnt(0)
    v_mfma_f32_32x32x16_bf16 v[112:127], v[140:143], v[180:183], v[112:127]
    ds_read_b128 v[136:139], v9 offset:192
    s_waitcnt lgkmcnt(0)
    v_mfma_f32_32x32x16_bf16 v[112:127], v[136:139], v[184:187], v[112:127]
    ds_read_b128 v[140:143], v9 offset:224
    s_waitcnt lgkmcnt(0)
    v_mfma_f32_32x32x16_bf16 v[112:127], v[140:143], v[188:191], v[112:127]
    ds_read_b128 v[136:139], v9 offset:256
    s_waitcnt lgkmcnt(0)
    v_mfma_f32_32x32x16_bf16 v[112:127], v[136:139], v[192:195], v[112:127]
    ds_read_b128 v[140:143], v9 offset:288
    s_waitcnt lgkmcnt(0)
    v_mfma_f32_32x32x16_bf16 v[112:127], v[140:143], v[196:199], v[112:127]
    ds_read_b128 v[136:139], v9 offset:320
    s_waitcnt lgkmcnt(0)
    v_mfma_f32_32x32x16_bf16 v[112:127], v[136:139], v[200:203], v[112:127]
    ds_read_b128 v[140:143], v9 offset:352
    s_waitcnt lgkmcnt(0)
    v_mfma_f32_32x32x16_bf16 v[112:127], v[140:143], v[204:207], v[112:127]
    s_nop 15
    s_nop 3
    s_cmp_lg_u32 s3, 0
    s_cbranch_scc1 attn_B0_w
    ds_write_b128 v12, v[112:115]
    ds_write_b128 v12, v[116:119] offset:16
    ds_write_b128 v12, v[120:123] offset:32
    ds_write_b128 v12, v[124:127] offset:48
    s_waitcnt lgkmcnt(0)
    s_barrier
    s_branch attn_B0_j

attn_B0_w:
    s_barrier
    ds_add_f32 v12, v112 offset:0
    ds_add_f32 v12, v113 offset:4
    ds_add_f32 v12, v114 offset:8
    ds_add_f32 v12, v115 offset:12
    ds_add_f32 v12, v116 offset:16
    ds_add_f32 v12, v117 offset:20
    ds_add_f32 v12, v118 offset:24
    ds_add_f32 v12, v119 offset:28
    ds_add_f32 v12, v120 offset:32
    ds_add_f32 v12, v121 offset:36
    ds_add_f32 v12, v122 offset:40
    ds_add_f32 v12, v123 offset:44
    ds_add_f32 v12, v124 offset:48
    ds_add_f32 v12, v125 offset:52
    ds_add_f32 v12, v126 offset:56
    ds_add_f32 v12, v127 offset:60
    s_waitcnt lgkmcnt(0)
attn_B0_j:
    s_barrier
    ds_read_b128 v[112:115], v12
    ds_read_b128 v[116:119], v12 offset:16
    ds_read_b128 v[120:123], v12 offset:32
    ds_read_b128 v[124:127], v12 offset:48
    s_waitcnt lgkmcnt(0)

    v_mul_f32 v112, s27, v112
    v_mul_f32 v113, s27, v113
    v_mul_f32 v114, s27, v114
    v_mul_f32 v115, s27, v115
    v_mul_f32 v116, s27, v116
    v_mul_f32 v117, s27, v117
    v_mul_f32 v118, s27, v118
    v_mul_f32 v119, s27, v119
    v_mul_f32 v120, s27, v120
    v_mul_f32 v121, s27, v121
    v_mul_f32 v122, s27, v122
    v_mul_f32 v123, s27, v123
    v_mul_f32 v124, s27, v124
    v_mul_f32 v125, s27, v125
    v_mul_f32 v126, s27, v126
    v_mul_f32 v127, s27, v127
    v_max3_f32 v144, v112, v113, v114
    v_max3_f32 v145, v115, v116, v117
    v_max3_f32 v146, v118, v119, v120
    v_max3_f32 v147, v121, v122, v123
    v_max3_f32 v144, v144, v124, v125
    v_max3_f32 v145, v145, v126, v127
    v_max3_f32 v144, v144, v145, v146
    v_max3_f32 v144, v144, v147, v14
    v_mov_b32 v145, v144
    s_nop 1
    v_permlane32_swap_b32 v145, v144
    s_nop 1
    v_max_f32 v144, v144, v145
    v_sub_f32 v145, v14, v144
    v_exp_f32 v145, v145
    v_mov_b32 v14, v144

    v_sub_f32 v112, v112, v144
    v_sub_f32 v113, v113, v144
    v_sub_f32 v114, v114, v144
    v_sub_f32 v115, v115, v144
    v_sub_f32 v116, v116, v144
    v_sub_f32 v117, v117, v144
    v_sub_f32 v118, v118, v144
    v_sub_f32 v119, v119, v144
    v_sub_f32 v120, v120, v144
    v_sub_f32 v121, v121, v144
    v_sub_f32 v122, v122, v144
    v_sub_f32 v123, v123, v144
    v_sub_f32 v124, v124, v144
    v_sub_f32 v125, v125, v144
    v_sub_f32 v126, v126, v144
    v_sub_f32 v127, v127, v144
    v_exp_f32 v112, v112
    v_exp_f32 v113, v113
    v_exp_f32 v114, v114
    v_exp_f32 v115, v115
    v_exp_f32 v116, v116
    v_exp_f32 v117, v117
    v_exp_f32 v118, v118
    v_exp_f32 v119, v119
    v_exp_f32 v120, v120
    v_exp_f32 v121, v121
    v_exp_f32 v122, v122
    v_exp_f32 v123, v123
    v_exp_f32 v124, v124
    v_exp_f32 v125, v125
    v_exp_f32 v126, v126
    v_exp_f32 v127, v127
    v_mul_f32 v16, v16, v145
    v_mul_f32 v17, v17, v145
    v_mul_f32 v18, v18, v145
    v_mul_f32 v19, v19, v145
    v_mul_f32 v20, v20, v145
    v_mul_f32 v21, v21, v145
    v_mul_f32 v22, v22, v145
    v_mul_f32 v23, v23, v145
    v_mul_f32 v24, v24, v145
    v_mul_f32 v25, v25, v145
    v_mul_f32 v26, v26, v145
    v_mul_f32 v27, v27, v145
    v_mul_f32 v28, v28, v145
    v_mul_f32 v29, v29, v145
    v_mul_f32 v30, v30, v145
    v_mul_f32 v31, v31, v145
    v_mul_f32 v32, v32, v145
    v_mul_f32 v33, v33, v145
    v_mul_f32 v34, v34, v145
    v_mul_f32 v35, v35, v145
    v_mul_f32 v36, v36, v145
    v_mul_f32 v37, v37, v145
    v_mul_f32 v38, v38, v145
    v_mul_f32 v39, v39, v145
    v_mul_f32 v40, v40, v145
    v_mul_f32 v41, v41, v145
    v_mul_f32 v42, v42, v145
    v_mul_f32 v43, v43, v145
    v_mul_f32 v44, v44, v145
    v_mul_f32 v45, v45, v145
    v_mul_f32 v46, v46, v145
    v_mul_f32 v47, v47, v145
    v_mul_f32 v48, v48, v145
    v_mul_f32 v49, v49, v145
    v_mul_f32 v50, v50, v145
    v_mul_f32 v51, v51, v145
    v_mul_f32 v52, v52, v145
    v_mul_f32 v53, v53, v145
    v_mul_f32 v54, v54, v145
    v_mul_f32 v55, v55, v145
    v_mul_f32 v56, v56, v145
    v_mul_f32 v57, v57, v145
    v_mul_f32 v58, v58, v145
    v_mul_f32 v59, v59, v145
    v_mul_f32 v60, v60, v145
    v_mul_f32 v61, v61, v145
    v_mul_f32 v62, v62, v145
    v_mul_f32 v63, v63, v145
    v_add_f32 v146, v112, v113
    v_add_f32 v146, v146, v114
    v_add_f32 v146, v146, v115
    v_add_f32 v146, v146, v116
    v_add_f32 v146, v146, v117
    v_add_f32 v146, v146, v118
    v_add_f32 v146, v146, v119
    v_add_f32 v146, v146, v120
    v_add_f32 v146, v146, v121
    v_add_f32 v146, v146, v122
    v_add_f32 v146, v146, v123
    v_add_f32 v146, v146, v124
    v_add_f32 v146, v146, v125
    v_add_f32 v146, v146, v126
    v_add_f32 v146, v146, v127
    v_mov_b32 v147, v146
    s_nop 1
    v_permlane32_swap_b32 v147, v146
    s_nop 1
    v_add_f32 v146, v146, v147
    v_fma_f32 v15, v15, v145, v146

    v_cvt_pk_bf16_f32 v128, v112, v113
    v_cvt_pk_bf16_f32 v129, v114, v115
    v_cvt_pk_bf16_f32 v130, v116, v117
    v_cvt_pk_bf16_f32 v131, v118, v119
    v_cvt_pk_bf16_f32 v132, v120, v121
    v_cvt_pk_bf16_f32 v133, v122, v123
    v_cvt_pk_bf16_f32 v134, v124, v125
    v_cvt_pk_bf16_f32 v135, v126, v127
    ds_read_b64_tr_b16 v[136:137], v11 offset:0
    ds_read_b64_tr_b16 v[138:139], v11 offset:12416
    ds_read_b64_tr_b16 v[140:141], v11 offset:24832
    ds_read_b64_tr_b16 v[142:143], v11 offset:37248
    s_waitcnt lgkmcnt(2)
    v_mfma_f32_32x32x16_bf16 v[16:31], v[136:139], v[128:131], v[16:31]
    s_waitcnt lgkmcnt(0)
    v_mfma_f32_32x32x16_bf16 v[16:31], v[140:143], v[132:135], v[16:31]
    s_nop 7
    ds_read_b64_tr_b16 v[136:137], v11 offset:64
    ds_read_b64_tr_b16 v[138:139], v11 offset:12480
    ds_read_b64_tr_b16 v[140:141], v11 offset:24896
    ds_read_b64_tr_b16 v[142:143], v11 offset:37312
    s_waitcnt lgkmcnt(2)
    v_mfma_f32_32x32x16_bf16 v[32:47], v[136:139], v[128:131], v[32:47]
    s_waitcnt lgkmcnt(0)
    v_mfma_f32_32x32x16_bf16 v[32:47], v[140:143], v[132:135], v[32:47]
    s_nop 7
    ds_read_b64_tr_b16 v[136:137], v11 offset:128
    ds_read_b64_tr_b16 v[138:139], v11 offset:12544
    ds_read_b64_tr_b16 v[140:141], v11 offset:24960
    ds_read_b64_tr_b16 v[142:143], v11 offset:37376
    s_waitcnt lgkmcnt(2)
    v_mfma_f32_32x32x16_bf16 v[48:63], v[136:139], v[128:131], v[48:63]
    s_waitcnt lgkmcnt(0)
    v_mfma_f32_32x32x16_bf16 v[48:63], v[140:143], v[132:135], v[48:63]
    s_nop 7
    s_nop 7
    s_barrier
    s_sub_u32 s30, s30, 1
    s_cmp_lg_u32 s30, 0
    s_cbranch_scc1 attn_Bloop
    s_waitcnt vmcnt(0)
    s_nop 15
    s_lshl_b32 s24, s6, 5
    v_add_u32 v5, s24, v4
    v_mul_u32_u24 v5, 3072, v5
    v_lshlrev_b32 v6, 4, v3
    v_add_u32 v5, v5, v6
    s_lshl_b32 s25, s22, 1
    s_add_u32 s25, s25, 1048576

    buffer_store_dwordx4 v[16:19], v5, s[8:11], s25 offen offset:0
    buffer_store_dwordx4 v[20:23], v5, s[8:11], s25 offen offset:32
    buffer_store_dwordx4 v[24:27], v5, s[8:11], s25 offen offset:64
    buffer_store_dwordx4 v[28:31], v5, s[8:11], s25 offen offset:96
    buffer_store_dwordx4 v[32:35], v5, s[8:11], s25 offen offset:128
    buffer_store_dwordx4 v[36:39], v5, s[8:11], s25 offen offset:160
    buffer_store_dwordx4 v[40:43], v5, s[8:11], s25 offen offset:192
    buffer_store_dwordx4 v[44:47], v5, s[8:11], s25 offen offset:224
    buffer_store_dwordx4 v[48:51], v5, s[8:11], s25 offen offset:256
    buffer_store_dwordx4 v[52:55], v5, s[8:11], s25 offen offset:288
    buffer_store_dwordx4 v[56:59], v5, s[8:11], s25 offen offset:320
    buffer_store_dwordx4 v[60:63], v5, s[8:11], s25 offen offset:352
    s_or_b32 s25, s7, s3
    s_cmp_lg_u32 s25, 0
    s_cbranch_scc1 attn_exit
    v_cmp_gt_u32 vcc, 32, v0
    s_and_saveexec_b64 s[28:29], vcc
    v_add_u32 v5, s24, v0
    v_lshlrev_b32 v5, 3, v5
    s_mov_b32 s25, 786432
    buffer_store_dwordx2 v[14:15], v5, s[8:11], s25 offen

attn_exit:
    s_endpgm
.p2align 8
.type comb_kernel,@function
comb_kernel:
    s_cmp_ge_u32 s2, 384
    s_cbranch_scc1 comb_exit
    s_load_dwordx2 s[4:5], s[0:1], 104
    v_lshrrev_b32 v1, 6, v0
    s_nop 0
    v_readfirstlane_b32 s3, v1
    v_and_b32 v2, 63, v0
    v_lshrrev_b32 v3, 5, v2
    v_and_b32 v4, 31, v2
    s_cmp_ge_u32 s2, 128
    s_cbranch_scc1 comb_B
    s_load_dwordx2 s[12:13], s[0:1], 32
    s_and_b32 s6, s2, 31
    s_lshr_b32 s7, s2, 5
    s_waitcnt lgkmcnt(0)

    s_mov_b32 s8, s4
    s_and_b32 s9, s5, 0xffff
    s_mov_b32 s10, 8388608
    s_mov_b32 s11, 0x00020000

    s_mov_b32 s16, s12
    s_and_b32 s17, s13, 0xffff
    s_mov_b32 s18, 7864320
    s_mov_b32 s19, 0x00020000

    s_lshl_b32 s24, s6, 13
    s_add_u32 s24, s24, 262144
    s_mul_i32 s25, s7, 192
    v_lshlrev_b32 v6, 2, v0
    v_add_u32 v6, s25, v6
    v_mov_b32 v7, 0

    buffer_load_dwordx2 v[160:161], v7, s[8:11], s24 offen offset:768
    buffer_load_dword v192, v6, s[8:11], s24 offen
    s_add_u32 s24, s24, 1024
    buffer_load_dwordx2 v[162:163], v7, s[8:11], s24 offen offset:768
    buffer_load_dword v193, v6, s[8:11], s24 offen
    s_add_u32 s24, s24, 1024
    buffer_load_dwordx2 v[164:165], v7, s[8:11], s24 offen offset:768
    buffer_load_dword v194, v6, s[8:11], s24 offen
    s_add_u32 s24, s24, 1024
    buffer_load_dwordx2 v[166:167], v7, s[8:11], s24 offen offset:768
    buffer_load_dword v195, v6, s[8:11], s24 offen
    s_add_u32 s24, s24, 1024
    buffer_load_dwordx2 v[168:169], v7, s[8:11], s24 offen offset:768
    buffer_load_dword v196, v6, s[8:11], s24 offen
    s_add_u32 s24, s24, 1024
    buffer_load_dwordx2 v[170:171], v7, s[8:11], s24 offen offset:768
    buffer_load_dword v197, v6, s[8:11], s24 offen
    s_add_u32 s24, s24, 1024
    buffer_load_dwordx2 v[172:173], v7, s[8:11], s24 offen offset:768
    buffer_load_dword v198, v6, s[8:11], s24 offen
    s_add_u32 s24, s24, 1024
    buffer_load_dwordx2 v[174:175], v7, s[8:11], s24 offen offset:768
    buffer_load_dword v199, v6, s[8:11], s24 offen
    s_add_u32 s24, s24, 1024
    s_mul_i32 s31, s6, 192
    s_mul_i32 s25, s7, 48
    s_add_u32 s31, s31, s25
    s_mul_i32 s25, s3, 12
    s_add_u32 s31, s31, s25
    s_mul_i32 s31, s31, 1280

    v_mul_u32_u24 v252, 20, v2
    buffer_load_dwordx4 v[16:19], v252, s[16:19], s31 offen
    buffer_load_dword v20, v252, s[16:19], s31 offen offset:16
    s_add_u32 s31, s31, 1280
    buffer_load_dwordx4 v[22:25], v252, s[16:19], s31 offen
    buffer_load_dword v26, v252, s[16:19], s31 offen offset:16
    s_add_u32 s31, s31, 1280
    buffer_load_dwordx4 v[28:31], v252, s[16:19], s31 offen
    buffer_load_dword v32, v252, s[16:19], s31 offen offset:16
    s_add_u32 s31, s31, 1280
    buffer_load_dwordx4 v[34:37], v252, s[16:19], s31 offen
    buffer_load_dword v38, v252, s[16:19], s31 offen offset:16
    s_add_u32 s31, s31, 1280
    buffer_load_dwordx4 v[40:43], v252, s[16:19], s31 offen
    buffer_load_dword v44, v252, s[16:19], s31 offen offset:16
    s_add_u32 s31, s31, 1280
    buffer_load_dwordx4 v[46:49], v252, s[16:19], s31 offen
    buffer_load_dword v50, v252, s[16:19], s31 offen offset:16
    s_add_u32 s31, s31, 1280
    buffer_load_dwordx4 v[52:55], v252, s[16:19], s31 offen
    buffer_load_dword v56, v252, s[16:19], s31 offen offset:16
    s_add_u32 s31, s31, 1280
    buffer_load_dwordx4 v[58:61], v252, s[16:19], s31 offen
    buffer_load_dword v62, v252, s[16:19], s31 offen offset:16
    s_add_u32 s31, s31, 1280
    buffer_load_dwordx4 v[64:67], v252, s[16:19], s31 offen
    buffer_load_dword v68, v252, s[16:19], s31 offen offset:16
    s_add_u32 s31, s31, 1280
    buffer_load_dwordx4 v[70:73], v252, s[16:19], s31 offen
    buffer_load_dword v74, v252, s[16:19], s31 offen offset:16
    s_add_u32 s31, s31, 1280
    buffer_load_dwordx4 v[76:79], v252, s[16:19], s31 offen
    buffer_load_dword v80, v252, s[16:19], s31 offen offset:16
    s_add_u32 s31, s31, 1280
    buffer_load_dwordx4 v[82:85], v252, s[16:19], s31 offen
    buffer_load_dword v86, v252, s[16:19], s31 offen offset:16
    s_add_u32 s31, s31, 1280
    s_waitcnt vmcnt(24)
    v_mov_b32 v8, v160
    v_max_f32 v8, v8, v162
    v_max_f32 v8, v8, v164
    v_max_f32 v8, v8, v166
    v_max_f32 v8, v8, v168
    v_max_f32 v8, v8, v170
    v_max_f32 v8, v8, v172
    v_max_f32 v8, v8, v174
    v_sub_f32 v160, v160, v8
    v_sub_f32 v162, v162, v8
    v_sub_f32 v164, v164, v8
    v_sub_f32 v166, v166, v8
    v_sub_f32 v168, v168, v8
    v_sub_f32 v170, v170, v8
    v_sub_f32 v172, v172, v8
    v_sub_f32 v174, v174, v8
    v_exp_f32 v160, v160
    v_exp_f32 v162, v162
    v_exp_f32 v164, v164
    v_exp_f32 v166, v166
    v_exp_f32 v168, v168
    v_exp_f32 v170, v170
    v_exp_f32 v172, v172
    v_exp_f32 v174, v174
    v_mov_b32 v9, 0
    v_mov_b32 v10, 0
    v_fmac_f32 v9, v160, v161
    v_fmac_f32 v10, v160, v192
    v_fmac_f32 v9, v162, v163
    v_fmac_f32 v10, v162, v193
    v_fmac_f32 v9, v164, v165
    v_fmac_f32 v10, v164, v194
    v_fmac_f32 v9, v166, v167
    v_fmac_f32 v10, v166, v195
    v_fmac_f32 v9, v168, v169
    v_fmac_f32 v10, v168, v196
    v_fmac_f32 v9, v170, v171
    v_fmac_f32 v10, v170, v197
    v_fmac_f32 v9, v172, v173
    v_fmac_f32 v10, v172, v198
    v_fmac_f32 v9, v174, v175
    v_fmac_f32 v10, v174, v199
    v_rcp_f32 v9, v9
    s_nop 0
    v_mul_f32 v10, v10, v9
    v_cvt_pk_bf16_f32 v10, v10, v10
    v_lshlrev_b32 v10, 16, v10
    v_lshlrev_b32 v6, 2, v0
    v_cmp_gt_u32 vcc, 48, v0
    s_and_saveexec_b64 s[28:29], vcc
    ds_write_b32 v6, v10
    s_mov_b64 exec, -1
    s_waitcnt lgkmcnt(0)
    s_barrier
    v_mul_u32_u24 v253, 48, v1

    ds_read_b32 v160, v253 offset:0
    ds_read_b32 v161, v253 offset:4
    ds_read_b32 v162, v253 offset:8
    ds_read_b32 v163, v253 offset:12
    ds_read_b32 v164, v253 offset:16
    ds_read_b32 v165, v253 offset:20
    ds_read_b32 v166, v253 offset:24
    ds_read_b32 v167, v253 offset:28
    ds_read_b32 v168, v253 offset:32
    ds_read_b32 v169, v253 offset:36
    ds_read_b32 v170, v253 offset:40
    ds_read_b32 v171, v253 offset:44
    v_mov_b32 v240, 0
    v_mov_b32 v241, 0
    v_mov_b32 v242, 0
    v_mov_b32 v243, 0
    v_mov_b32 v244, 0
    v_mov_b32 v245, 0
    v_mov_b32 v246, 0
    v_mov_b32 v247, 0
    v_mov_b32 v248, 0
    v_mov_b32 v249, 0
    s_waitcnt lgkmcnt(0)
    s_waitcnt vmcnt(22)
    v_lshlrev_b32 v6, 16, v16
    v_and_b32 v7, 0xffff0000, v16
    v_fmac_f32 v240, v6, v160
    v_fmac_f32 v241, v7, v160
    v_lshlrev_b32 v6, 16, v17
    v_and_b32 v7, 0xffff0000, v17
    v_fmac_f32 v242, v6, v160
    v_fmac_f32 v243, v7, v160
    v_lshlrev_b32 v6, 16, v18
    v_and_b32 v7, 0xffff0000, v18
    v_fmac_f32 v244, v6, v160
    v_fmac_f32 v245, v7, v160
    v_lshlrev_b32 v6, 16, v19
    v_and_b32 v7, 0xffff0000, v19
    v_fmac_f32 v246, v6, v160
    v_fmac_f32 v247, v7, v160
    v_lshlrev_b32 v6, 16, v20
    v_and_b32 v7, 0xffff0000, v20
    v_fmac_f32 v248, v6, v160
    v_fmac_f32 v249, v7, v160
    s_waitcnt vmcnt(20)
    v_lshlrev_b32 v6, 16, v22
    v_and_b32 v7, 0xffff0000, v22
    v_fmac_f32 v240, v6, v161
    v_fmac_f32 v241, v7, v161
    v_lshlrev_b32 v6, 16, v23
    v_and_b32 v7, 0xffff0000, v23
    v_fmac_f32 v242, v6, v161
    v_fmac_f32 v243, v7, v161
    v_lshlrev_b32 v6, 16, v24
    v_and_b32 v7, 0xffff0000, v24
    v_fmac_f32 v244, v6, v161
    v_fmac_f32 v245, v7, v161
    v_lshlrev_b32 v6, 16, v25
    v_and_b32 v7, 0xffff0000, v25
    v_fmac_f32 v246, v6, v161
    v_fmac_f32 v247, v7, v161
    v_lshlrev_b32 v6, 16, v26
    v_and_b32 v7, 0xffff0000, v26
    v_fmac_f32 v248, v6, v161
    v_fmac_f32 v249, v7, v161
    s_waitcnt vmcnt(18)
    v_lshlrev_b32 v6, 16, v28
    v_and_b32 v7, 0xffff0000, v28
    v_fmac_f32 v240, v6, v162
    v_fmac_f32 v241, v7, v162
    v_lshlrev_b32 v6, 16, v29
    v_and_b32 v7, 0xffff0000, v29
    v_fmac_f32 v242, v6, v162
    v_fmac_f32 v243, v7, v162
    v_lshlrev_b32 v6, 16, v30
    v_and_b32 v7, 0xffff0000, v30
    v_fmac_f32 v244, v6, v162
    v_fmac_f32 v245, v7, v162
    v_lshlrev_b32 v6, 16, v31
    v_and_b32 v7, 0xffff0000, v31
    v_fmac_f32 v246, v6, v162
    v_fmac_f32 v247, v7, v162
    v_lshlrev_b32 v6, 16, v32
    v_and_b32 v7, 0xffff0000, v32
    v_fmac_f32 v248, v6, v162
    v_fmac_f32 v249, v7, v162
    s_waitcnt vmcnt(16)
    v_lshlrev_b32 v6, 16, v34
    v_and_b32 v7, 0xffff0000, v34
    v_fmac_f32 v240, v6, v163
    v_fmac_f32 v241, v7, v163
    v_lshlrev_b32 v6, 16, v35
    v_and_b32 v7, 0xffff0000, v35
    v_fmac_f32 v242, v6, v163
    v_fmac_f32 v243, v7, v163
    v_lshlrev_b32 v6, 16, v36
    v_and_b32 v7, 0xffff0000, v36
    v_fmac_f32 v244, v6, v163
    v_fmac_f32 v245, v7, v163
    v_lshlrev_b32 v6, 16, v37
    v_and_b32 v7, 0xffff0000, v37
    v_fmac_f32 v246, v6, v163
    v_fmac_f32 v247, v7, v163
    v_lshlrev_b32 v6, 16, v38
    v_and_b32 v7, 0xffff0000, v38
    v_fmac_f32 v248, v6, v163
    v_fmac_f32 v249, v7, v163
    s_waitcnt vmcnt(14)
    v_lshlrev_b32 v6, 16, v40
    v_and_b32 v7, 0xffff0000, v40
    v_fmac_f32 v240, v6, v164
    v_fmac_f32 v241, v7, v164
    v_lshlrev_b32 v6, 16, v41
    v_and_b32 v7, 0xffff0000, v41
    v_fmac_f32 v242, v6, v164
    v_fmac_f32 v243, v7, v164
    v_lshlrev_b32 v6, 16, v42
    v_and_b32 v7, 0xffff0000, v42
    v_fmac_f32 v244, v6, v164
    v_fmac_f32 v245, v7, v164
    v_lshlrev_b32 v6, 16, v43
    v_and_b32 v7, 0xffff0000, v43
    v_fmac_f32 v246, v6, v164
    v_fmac_f32 v247, v7, v164
    v_lshlrev_b32 v6, 16, v44
    v_and_b32 v7, 0xffff0000, v44
    v_fmac_f32 v248, v6, v164
    v_fmac_f32 v249, v7, v164
    s_waitcnt vmcnt(12)
    v_lshlrev_b32 v6, 16, v46
    v_and_b32 v7, 0xffff0000, v46
    v_fmac_f32 v240, v6, v165
    v_fmac_f32 v241, v7, v165
    v_lshlrev_b32 v6, 16, v47
    v_and_b32 v7, 0xffff0000, v47
    v_fmac_f32 v242, v6, v165
    v_fmac_f32 v243, v7, v165
    v_lshlrev_b32 v6, 16, v48
    v_and_b32 v7, 0xffff0000, v48
    v_fmac_f32 v244, v6, v165
    v_fmac_f32 v245, v7, v165
    v_lshlrev_b32 v6, 16, v49
    v_and_b32 v7, 0xffff0000, v49
    v_fmac_f32 v246, v6, v165
    v_fmac_f32 v247, v7, v165
    v_lshlrev_b32 v6, 16, v50
    v_and_b32 v7, 0xffff0000, v50
    v_fmac_f32 v248, v6, v165
    v_fmac_f32 v249, v7, v165
    s_waitcnt vmcnt(10)
    v_lshlrev_b32 v6, 16, v52
    v_and_b32 v7, 0xffff0000, v52
    v_fmac_f32 v240, v6, v166
    v_fmac_f32 v241, v7, v166
    v_lshlrev_b32 v6, 16, v53
    v_and_b32 v7, 0xffff0000, v53
    v_fmac_f32 v242, v6, v166
    v_fmac_f32 v243, v7, v166
    v_lshlrev_b32 v6, 16, v54
    v_and_b32 v7, 0xffff0000, v54
    v_fmac_f32 v244, v6, v166
    v_fmac_f32 v245, v7, v166
    v_lshlrev_b32 v6, 16, v55
    v_and_b32 v7, 0xffff0000, v55
    v_fmac_f32 v246, v6, v166
    v_fmac_f32 v247, v7, v166
    v_lshlrev_b32 v6, 16, v56
    v_and_b32 v7, 0xffff0000, v56
    v_fmac_f32 v248, v6, v166
    v_fmac_f32 v249, v7, v166
    s_waitcnt vmcnt(8)
    v_lshlrev_b32 v6, 16, v58
    v_and_b32 v7, 0xffff0000, v58
    v_fmac_f32 v240, v6, v167
    v_fmac_f32 v241, v7, v167
    v_lshlrev_b32 v6, 16, v59
    v_and_b32 v7, 0xffff0000, v59
    v_fmac_f32 v242, v6, v167
    v_fmac_f32 v243, v7, v167
    v_lshlrev_b32 v6, 16, v60
    v_and_b32 v7, 0xffff0000, v60
    v_fmac_f32 v244, v6, v167
    v_fmac_f32 v245, v7, v167
    v_lshlrev_b32 v6, 16, v61
    v_and_b32 v7, 0xffff0000, v61
    v_fmac_f32 v246, v6, v167
    v_fmac_f32 v247, v7, v167
    v_lshlrev_b32 v6, 16, v62
    v_and_b32 v7, 0xffff0000, v62
    v_fmac_f32 v248, v6, v167
    v_fmac_f32 v249, v7, v167
    s_waitcnt vmcnt(6)
    v_lshlrev_b32 v6, 16, v64
    v_and_b32 v7, 0xffff0000, v64
    v_fmac_f32 v240, v6, v168
    v_fmac_f32 v241, v7, v168
    v_lshlrev_b32 v6, 16, v65
    v_and_b32 v7, 0xffff0000, v65
    v_fmac_f32 v242, v6, v168
    v_fmac_f32 v243, v7, v168
    v_lshlrev_b32 v6, 16, v66
    v_and_b32 v7, 0xffff0000, v66
    v_fmac_f32 v244, v6, v168
    v_fmac_f32 v245, v7, v168
    v_lshlrev_b32 v6, 16, v67
    v_and_b32 v7, 0xffff0000, v67
    v_fmac_f32 v246, v6, v168
    v_fmac_f32 v247, v7, v168
    v_lshlrev_b32 v6, 16, v68
    v_and_b32 v7, 0xffff0000, v68
    v_fmac_f32 v248, v6, v168
    v_fmac_f32 v249, v7, v168
    s_waitcnt vmcnt(4)
    v_lshlrev_b32 v6, 16, v70
    v_and_b32 v7, 0xffff0000, v70
    v_fmac_f32 v240, v6, v169
    v_fmac_f32 v241, v7, v169
    v_lshlrev_b32 v6, 16, v71
    v_and_b32 v7, 0xffff0000, v71
    v_fmac_f32 v242, v6, v169
    v_fmac_f32 v243, v7, v169
    v_lshlrev_b32 v6, 16, v72
    v_and_b32 v7, 0xffff0000, v72
    v_fmac_f32 v244, v6, v169
    v_fmac_f32 v245, v7, v169
    v_lshlrev_b32 v6, 16, v73
    v_and_b32 v7, 0xffff0000, v73
    v_fmac_f32 v246, v6, v169
    v_fmac_f32 v247, v7, v169
    v_lshlrev_b32 v6, 16, v74
    v_and_b32 v7, 0xffff0000, v74
    v_fmac_f32 v248, v6, v169
    v_fmac_f32 v249, v7, v169
    s_waitcnt vmcnt(2)
    v_lshlrev_b32 v6, 16, v76
    v_and_b32 v7, 0xffff0000, v76
    v_fmac_f32 v240, v6, v170
    v_fmac_f32 v241, v7, v170
    v_lshlrev_b32 v6, 16, v77
    v_and_b32 v7, 0xffff0000, v77
    v_fmac_f32 v242, v6, v170
    v_fmac_f32 v243, v7, v170
    v_lshlrev_b32 v6, 16, v78
    v_and_b32 v7, 0xffff0000, v78
    v_fmac_f32 v244, v6, v170
    v_fmac_f32 v245, v7, v170
    v_lshlrev_b32 v6, 16, v79
    v_and_b32 v7, 0xffff0000, v79
    v_fmac_f32 v246, v6, v170
    v_fmac_f32 v247, v7, v170
    v_lshlrev_b32 v6, 16, v80
    v_and_b32 v7, 0xffff0000, v80
    v_fmac_f32 v248, v6, v170
    v_fmac_f32 v249, v7, v170
    s_waitcnt vmcnt(0)
    v_lshlrev_b32 v6, 16, v82
    v_and_b32 v7, 0xffff0000, v82
    v_fmac_f32 v240, v6, v171
    v_fmac_f32 v241, v7, v171
    v_lshlrev_b32 v6, 16, v83
    v_and_b32 v7, 0xffff0000, v83
    v_fmac_f32 v242, v6, v171
    v_fmac_f32 v243, v7, v171
    v_lshlrev_b32 v6, 16, v84
    v_and_b32 v7, 0xffff0000, v84
    v_fmac_f32 v244, v6, v171
    v_fmac_f32 v245, v7, v171
    v_lshlrev_b32 v6, 16, v85
    v_and_b32 v7, 0xffff0000, v85
    v_fmac_f32 v246, v6, v171
    v_fmac_f32 v247, v7, v171
    v_lshlrev_b32 v6, 16, v86
    v_and_b32 v7, 0xffff0000, v86
    v_fmac_f32 v248, v6, v171
    v_fmac_f32 v249, v7, v171
    v_mul_u32_u24 v6, 2560, v1
    v_mul_u32_u24 v7, 40, v2
    v_add_u32 v6, v6, v7
    s_barrier
    ds_write_b64 v6, v[240:241] offset:4096
    ds_write_b64 v6, v[242:243] offset:4104
    ds_write_b64 v6, v[244:245] offset:4112
    ds_write_b64 v6, v[246:247] offset:4120
    ds_write_b64 v6, v[248:249] offset:4128
    s_waitcnt lgkmcnt(0)
    s_barrier
    v_cmp_gt_u32 vcc, 160, v0
    s_and_saveexec_b64 s[28:29], vcc
    s_cbranch_execz comb_exit
    v_lshlrev_b32 v6, 4, v0
    ds_read_b128 v[16:19], v6 offset:4096
    ds_read_b128 v[20:23], v6 offset:6656
    ds_read_b128 v[24:27], v6 offset:9216
    ds_read_b128 v[28:31], v6 offset:11776
    s_mul_i32 s24, s2, 2560
    s_add_u32 s24, s24, 7340032
    s_waitcnt lgkmcnt(0)

    v_add_f32 v16, v16, v20
    v_add_f32 v24, v24, v28
    v_add_f32 v16, v16, v24
    v_add_f32 v17, v17, v21
    v_add_f32 v25, v25, v29
    v_add_f32 v17, v17, v25
    v_add_f32 v18, v18, v22
    v_add_f32 v26, v26, v30
    v_add_f32 v18, v18, v26
    v_add_f32 v19, v19, v23
    v_add_f32 v27, v27, v31
    v_add_f32 v19, v19, v27
    buffer_store_dwordx4 v[16:19], v6, s[8:11], s24 offen
    s_branch comb_exit

comb_B:
    s_load_dwordx2 s[12:13], s[0:1], 72
    s_load_dwordx2 s[14:15], s[0:1], 80
    s_sub_u32 s7, s2, 128
    s_and_b32 s6, s7, 31
    s_lshr_b32 s7, s7, 5
    s_waitcnt lgkmcnt(0)

    s_mov_b32 s8, s4
    s_and_b32 s9, s5, 0xffff
    s_mov_b32 s10, 8388608
    s_mov_b32 s11, 0x00020000

    s_mov_b32 s16, s12
    s_and_b32 s17, s13, 0xffff
    s_mov_b32 s18, 9437184
    s_mov_b32 s19, 0x00020000

    s_mov_b32 s20, s14
    s_and_b32 s21, s15, 0xffff
    s_mov_b32 s22, 7864320
    s_mov_b32 s23, 0x00020000

    s_lshl_b32 s24, s6, 3
    s_add_u32 s24, s24, 786432
    v_lshlrev_b32 v6, 8, v2
    buffer_load_dwordx2 v[8:9], v6, s[8:11], s24 offen
    s_mul_i32 s24, s3, 1572864
    s_mul_i32 s25, s6, 3072
    s_add_u32 s24, s24, s25
    s_mul_i32 s25, s7, 384
    s_add_u32 s24, s24, s25
    s_add_u32 s24, s24, 1048576
    v_lshlrev_b32 v6, 3, v2

    buffer_load_dwordx2 v[160:161], v6, s[8:11], s24 offen
    s_add_u32 s24, s24, 98304
    buffer_load_dwordx2 v[162:163], v6, s[8:11], s24 offen
    s_add_u32 s24, s24, 98304
    buffer_load_dwordx2 v[164:165], v6, s[8:11], s24 offen
    s_add_u32 s24, s24, 98304
    buffer_load_dwordx2 v[166:167], v6, s[8:11], s24 offen
    s_add_u32 s24, s24, 98304
    buffer_load_dwordx2 v[168:169], v6, s[8:11], s24 offen
    s_add_u32 s24, s24, 98304
    buffer_load_dwordx2 v[170:171], v6, s[8:11], s24 offen
    s_add_u32 s24, s24, 98304
    buffer_load_dwordx2 v[172:173], v6, s[8:11], s24 offen
    s_add_u32 s24, s24, 98304
    buffer_load_dwordx2 v[174:175], v6, s[8:11], s24 offen
    s_add_u32 s24, s24, 98304
    buffer_load_dwordx2 v[176:177], v6, s[8:11], s24 offen
    s_add_u32 s24, s24, 98304
    buffer_load_dwordx2 v[178:179], v6, s[8:11], s24 offen
    s_add_u32 s24, s24, 98304
    buffer_load_dwordx2 v[180:181], v6, s[8:11], s24 offen
    s_add_u32 s24, s24, 98304
    buffer_load_dwordx2 v[182:183], v6, s[8:11], s24 offen
    s_add_u32 s24, s24, 98304
    buffer_load_dwordx2 v[184:185], v6, s[8:11], s24 offen
    s_add_u32 s24, s24, 98304
    buffer_load_dwordx2 v[186:187], v6, s[8:11], s24 offen
    s_add_u32 s24, s24, 98304
    buffer_load_dwordx2 v[188:189], v6, s[8:11], s24 offen
    s_add_u32 s24, s24, 98304
    buffer_load_dwordx2 v[190:191], v6, s[8:11], s24 offen
    s_add_u32 s24, s24, 98304
    s_mul_i32 s24, s7, 96
    s_mul_i32 s25, s3, 24
    s_add_u32 s24, s24, s25
    s_mul_i32 s24, s24, 12288
    s_mul_i32 s25, s6, 384
    s_add_u32 s24, s24, s25
    v_mul_u32_u24 v5, 12, v4
    v_mul_u32_u24 v7, 12288, v3
    v_add_u32 v7, v7, v5

    buffer_load_dwordx3 v[192:194], v7, s[16:19], s24 offen
    s_add_u32 s24, s24, 24576
    buffer_load_dwordx3 v[196:198], v7, s[16:19], s24 offen
    s_add_u32 s24, s24, 24576
    buffer_load_dwordx3 v[200:202], v7, s[16:19], s24 offen
    s_add_u32 s24, s24, 24576
    buffer_load_dwordx3 v[204:206], v7, s[16:19], s24 offen
    s_add_u32 s24, s24, 24576
    buffer_load_dwordx3 v[208:210], v7, s[16:19], s24 offen
    s_add_u32 s24, s24, 24576
    buffer_load_dwordx3 v[212:214], v7, s[16:19], s24 offen
    s_add_u32 s24, s24, 24576
    buffer_load_dwordx3 v[216:218], v7, s[16:19], s24 offen
    s_add_u32 s24, s24, 24576
    buffer_load_dwordx3 v[220:222], v7, s[16:19], s24 offen
    s_add_u32 s24, s24, 24576
    buffer_load_dwordx3 v[224:226], v7, s[16:19], s24 offen
    s_add_u32 s24, s24, 24576
    buffer_load_dwordx3 v[228:230], v7, s[16:19], s24 offen
    s_add_u32 s24, s24, 24576
    buffer_load_dwordx3 v[232:234], v7, s[16:19], s24 offen
    s_add_u32 s24, s24, 24576
    buffer_load_dwordx3 v[236:238], v7, s[16:19], s24 offen
    s_add_u32 s24, s24, 24576
    s_mul_i32 s31, s6, 192
    s_mul_i32 s25, s3, 48
    s_add_u32 s31, s31, s25
    s_mul_i32 s31, s31, 1280

    s_waitcnt vmcnt(28)
    v_mov_b32 v10, v8
    v_mov_b32 v11, v8
    v_mov_b32 v12, v8
    s_nop 1

    v_max_f32_dpp v10, v10, v10 quad_perm:[1,0,3,2] row_mask:0xf bank_mask:0xf
    v_max_f32_dpp v11, v11, v11 quad_perm:[1,0,3,2] row_mask:0xf bank_mask:0xf
    v_max_f32_dpp v12, v12, v12 quad_perm:[1,0,3,2] row_mask:0xf bank_mask:0xf
    v_max_f32_dpp v10, v10, v10 quad_perm:[2,3,0,1] row_mask:0xf bank_mask:0xf
    v_max_f32_dpp v11, v11, v11 quad_perm:[2,3,0,1] row_mask:0xf bank_mask:0xf
    v_max_f32_dpp v12, v12, v12 quad_perm:[2,3,0,1] row_mask:0xf bank_mask:0xf
    v_max_f32_dpp v10, v10, v10 row_half_mirror row_mask:0xf bank_mask:0xf
    v_max_f32_dpp v11, v11, v11 row_half_mirror row_mask:0xf bank_mask:0xf
    v_max_f32_dpp v12, v12, v12 row_half_mirror row_mask:0xf bank_mask:0xf
    v_max_f32_dpp v10, v10, v10 row_mirror row_mask:0xf bank_mask:0xf
    v_max_f32_dpp v11, v11, v11 row_mirror row_mask:0xf bank_mask:0xf
    v_max_f32_dpp v12, v12, v12 row_mirror row_mask:0xf bank_mask:0xf
    v_mov_b32 v13, v10
    v_mov_b32 v14, v11
    v_mov_b32 v15, v12
    s_nop 1
    v_permlane16_swap_b32 v13, v10
    v_permlane16_swap_b32 v14, v11
    v_permlane16_swap_b32 v15, v12
    s_nop 1
    v_max_f32 v10, v10, v13
    v_max_f32 v11, v11, v14
    v_max_f32 v12, v12, v15
    v_mov_b32 v11, v10
    s_nop 1
    v_permlane32_swap_b32 v11, v10
    s_nop 1
    v_max_f32 v10, v10, v11
    v_sub_f32 v8, v8, v10
    v_exp_f32 v8, v8
    s_nop 0
    v_mul_f32 v10, v8, v9
    v_mov_b32 v11, v10
    v_mov_b32 v12, v10
    s_nop 1

    v_add_f32_dpp v10, v10, v10 quad_perm:[1,0,3,2] row_mask:0xf bank_mask:0xf
    v_add_f32_dpp v11, v11, v11 quad_perm:[1,0,3,2] row_mask:0xf bank_mask:0xf
    v_add_f32_dpp v12, v12, v12 quad_perm:[1,0,3,2] row_mask:0xf bank_mask:0xf
    v_add_f32_dpp v10, v10, v10 quad_perm:[2,3,0,1] row_mask:0xf bank_mask:0xf
    v_add_f32_dpp v11, v11, v11 quad_perm:[2,3,0,1] row_mask:0xf bank_mask:0xf
    v_add_f32_dpp v12, v12, v12 quad_perm:[2,3,0,1] row_mask:0xf bank_mask:0xf
    v_add_f32_dpp v10, v10, v10 row_half_mirror row_mask:0xf bank_mask:0xf
    v_add_f32_dpp v11, v11, v11 row_half_mirror row_mask:0xf bank_mask:0xf
    v_add_f32_dpp v12, v12, v12 row_half_mirror row_mask:0xf bank_mask:0xf
    v_add_f32_dpp v10, v10, v10 row_mirror row_mask:0xf bank_mask:0xf
    v_add_f32_dpp v11, v11, v11 row_mirror row_mask:0xf bank_mask:0xf
    v_add_f32_dpp v12, v12, v12 row_mirror row_mask:0xf bank_mask:0xf
    v_mov_b32 v13, v10
    v_mov_b32 v14, v11
    v_mov_b32 v15, v12
    s_nop 1
    v_permlane16_swap_b32 v13, v10
    v_permlane16_swap_b32 v14, v11
    v_permlane16_swap_b32 v15, v12
    s_nop 1
    v_add_f32 v10, v10, v13
    v_add_f32 v11, v11, v14
    v_add_f32 v12, v12, v15
    v_mov_b32 v11, v10
    s_nop 1
    v_permlane32_swap_b32 v11, v10
    s_nop 1
    v_add_f32 v10, v10, v11
    v_rcp_f32 v10, v10
    s_nop 0
    v_mul_f32 v8, v8, v10
    v_lshlrev_b32 v6, 2, v2
    ds_write_b32 v6, v8 offset:2048
    s_waitcnt lgkmcnt(0)
    s_barrier
    v_lshlrev_b32 v6, 6, v1

    ds_read_b32 v112, v6 offset:2048
    ds_read_b32 v113, v6 offset:2052
    ds_read_b32 v114, v6 offset:2056
    ds_read_b32 v115, v6 offset:2060
    ds_read_b32 v116, v6 offset:2064
    ds_read_b32 v117, v6 offset:2068
    ds_read_b32 v118, v6 offset:2072
    ds_read_b32 v119, v6 offset:2076
    ds_read_b32 v120, v6 offset:2080
    ds_read_b32 v121, v6 offset:2084
    ds_read_b32 v122, v6 offset:2088
    ds_read_b32 v123, v6 offset:2092
    ds_read_b32 v124, v6 offset:2096
    ds_read_b32 v125, v6 offset:2100
    ds_read_b32 v126, v6 offset:2104
    ds_read_b32 v127, v6 offset:2108
    s_waitcnt vmcnt(12) lgkmcnt(0)
    v_mov_b32 v10, 0
    v_mov_b32 v11, 0
    v_fmac_f32 v10, v160, v112
    v_fmac_f32 v11, v161, v112
    v_fmac_f32 v10, v162, v113
    v_fmac_f32 v11, v163, v113
    v_fmac_f32 v10, v164, v114
    v_fmac_f32 v11, v165, v114
    v_fmac_f32 v10, v166, v115
    v_fmac_f32 v11, v167, v115
    v_fmac_f32 v10, v168, v116
    v_fmac_f32 v11, v169, v116
    v_fmac_f32 v10, v170, v117
    v_fmac_f32 v11, v171, v117
    v_fmac_f32 v10, v172, v118
    v_fmac_f32 v11, v173, v118
    v_fmac_f32 v10, v174, v119
    v_fmac_f32 v11, v175, v119
    v_fmac_f32 v10, v176, v120
    v_fmac_f32 v11, v177, v120
    v_fmac_f32 v10, v178, v121
    v_fmac_f32 v11, v179, v121
    v_fmac_f32 v10, v180, v122
    v_fmac_f32 v11, v181, v122
    v_fmac_f32 v10, v182, v123
    v_fmac_f32 v11, v183, v123
    v_fmac_f32 v10, v184, v124
    v_fmac_f32 v11, v185, v124
    v_fmac_f32 v10, v186, v125
    v_fmac_f32 v11, v187, v125
    v_fmac_f32 v10, v188, v126
    v_fmac_f32 v11, v189, v126
    v_fmac_f32 v10, v190, v127
    v_fmac_f32 v11, v191, v127
    v_mul_u32_u24 v6, 384, v1
    v_lshlrev_b32 v8, 3, v2
    v_add_u32 v6, v6, v8
    v_cmp_gt_u32 vcc, 48, v2
    s_and_saveexec_b64 s[28:29], vcc
    ds_write_b64 v6, v[10:11] offset:2304
    s_mov_b64 exec, -1
    s_waitcnt lgkmcnt(0)
    s_barrier
    v_mul_u32_u24 v6, 96, v1
    v_lshlrev_b32 v8, 2, v3
    v_add_u32 v6, v6, v8

    ds_read_b32 v112, v6 offset:2304
    ds_read_b32 v113, v6 offset:2688
    ds_read_b32 v114, v6 offset:3072
    ds_read_b32 v115, v6 offset:3456
    ds_read_b32 v116, v6 offset:2312
    ds_read_b32 v117, v6 offset:2696
    ds_read_b32 v118, v6 offset:3080
    ds_read_b32 v119, v6 offset:3464
    ds_read_b32 v120, v6 offset:2320
    ds_read_b32 v121, v6 offset:2704
    ds_read_b32 v122, v6 offset:3088
    ds_read_b32 v123, v6 offset:3472
    ds_read_b32 v124, v6 offset:2328
    ds_read_b32 v125, v6 offset:2712
    ds_read_b32 v126, v6 offset:3096
    ds_read_b32 v127, v6 offset:3480
    ds_read_b32 v128, v6 offset:2336
    ds_read_b32 v129, v6 offset:2720
    ds_read_b32 v130, v6 offset:3104
    ds_read_b32 v131, v6 offset:3488
    ds_read_b32 v132, v6 offset:2344
    ds_read_b32 v133, v6 offset:2728
    ds_read_b32 v134, v6 offset:3112
    ds_read_b32 v135, v6 offset:3496
    ds_read_b32 v136, v6 offset:2352
    ds_read_b32 v137, v6 offset:2736
    ds_read_b32 v138, v6 offset:3120
    ds_read_b32 v139, v6 offset:3504
    ds_read_b32 v140, v6 offset:2360
    ds_read_b32 v141, v6 offset:2744
    ds_read_b32 v142, v6 offset:3128
    ds_read_b32 v143, v6 offset:3512
    ds_read_b32 v144, v6 offset:2368
    ds_read_b32 v145, v6 offset:2752
    ds_read_b32 v146, v6 offset:3136
    ds_read_b32 v147, v6 offset:3520
    ds_read_b32 v148, v6 offset:2376
    ds_read_b32 v149, v6 offset:2760
    ds_read_b32 v150, v6 offset:3144
    ds_read_b32 v151, v6 offset:3528
    ds_read_b32 v152, v6 offset:2384
    ds_read_b32 v153, v6 offset:2768
    ds_read_b32 v154, v6 offset:3152
    ds_read_b32 v155, v6 offset:3536
    ds_read_b32 v156, v6 offset:2392
    ds_read_b32 v157, v6 offset:2776
    ds_read_b32 v158, v6 offset:3160
    ds_read_b32 v159, v6 offset:3544
    s_waitcnt lgkmcnt(0)
    v_add_f32 v112, v112, v113
    v_add_f32 v114, v114, v115
    v_add_f32 v112, v112, v114
    v_add_f32 v116, v116, v117
    v_add_f32 v118, v118, v119
    v_add_f32 v116, v116, v118
    v_add_f32 v120, v120, v121
    v_add_f32 v122, v122, v123
    v_add_f32 v120, v120, v122
    v_add_f32 v124, v124, v125
    v_add_f32 v126, v126, v127
    v_add_f32 v124, v124, v126
    v_add_f32 v128, v128, v129
    v_add_f32 v130, v130, v131
    v_add_f32 v128, v128, v130
    v_add_f32 v132, v132, v133
    v_add_f32 v134, v134, v135
    v_add_f32 v132, v132, v134
    v_add_f32 v136, v136, v137
    v_add_f32 v138, v138, v139
    v_add_f32 v136, v136, v138
    v_add_f32 v140, v140, v141
    v_add_f32 v142, v142, v143
    v_add_f32 v140, v140, v142
    v_add_f32 v144, v144, v145
    v_add_f32 v146, v146, v147
    v_add_f32 v144, v144, v146
    v_add_f32 v148, v148, v149
    v_add_f32 v150, v150, v151
    v_add_f32 v148, v148, v150
    v_add_f32 v152, v152, v153
    v_add_f32 v154, v154, v155
    v_add_f32 v152, v152, v154
    v_add_f32 v156, v156, v157
    v_add_f32 v158, v158, v159
    v_add_f32 v156, v156, v158
    v_mov_b32 v10, 0
    v_mov_b32 v11, 0
    v_mov_b32 v12, 0
    v_mov_b32 v13, 0
    v_mov_b32 v14, 0
    v_mov_b32 v15, 0
    s_waitcnt vmcnt(11)
    v_lshlrev_b32 v8, 16, v192
    v_and_b32 v9, 0xffff0000, v192
    v_fmac_f32 v10, v8, v112
    v_fmac_f32 v11, v9, v112
    v_lshlrev_b32 v8, 16, v193
    v_and_b32 v9, 0xffff0000, v193
    v_fmac_f32 v12, v8, v112
    v_fmac_f32 v13, v9, v112
    v_lshlrev_b32 v8, 16, v194
    v_and_b32 v9, 0xffff0000, v194
    v_fmac_f32 v14, v8, v112
    v_fmac_f32 v15, v9, v112
    s_waitcnt vmcnt(10)
    v_lshlrev_b32 v8, 16, v196
    v_and_b32 v9, 0xffff0000, v196
    v_fmac_f32 v10, v8, v116
    v_fmac_f32 v11, v9, v116
    v_lshlrev_b32 v8, 16, v197
    v_and_b32 v9, 0xffff0000, v197
    v_fmac_f32 v12, v8, v116
    v_fmac_f32 v13, v9, v116
    v_lshlrev_b32 v8, 16, v198
    v_and_b32 v9, 0xffff0000, v198
    v_fmac_f32 v14, v8, v116
    v_fmac_f32 v15, v9, v116
    s_waitcnt vmcnt(9)
    v_lshlrev_b32 v8, 16, v200
    v_and_b32 v9, 0xffff0000, v200
    v_fmac_f32 v10, v8, v120
    v_fmac_f32 v11, v9, v120
    v_lshlrev_b32 v8, 16, v201
    v_and_b32 v9, 0xffff0000, v201
    v_fmac_f32 v12, v8, v120
    v_fmac_f32 v13, v9, v120
    v_lshlrev_b32 v8, 16, v202
    v_and_b32 v9, 0xffff0000, v202
    v_fmac_f32 v14, v8, v120
    v_fmac_f32 v15, v9, v120
    s_waitcnt vmcnt(8)
    v_lshlrev_b32 v8, 16, v204
    v_and_b32 v9, 0xffff0000, v204
    v_fmac_f32 v10, v8, v124
    v_fmac_f32 v11, v9, v124
    v_lshlrev_b32 v8, 16, v205
    v_and_b32 v9, 0xffff0000, v205
    v_fmac_f32 v12, v8, v124
    v_fmac_f32 v13, v9, v124
    v_lshlrev_b32 v8, 16, v206
    v_and_b32 v9, 0xffff0000, v206
    v_fmac_f32 v14, v8, v124
    v_fmac_f32 v15, v9, v124
    s_waitcnt vmcnt(7)
    v_lshlrev_b32 v8, 16, v208
    v_and_b32 v9, 0xffff0000, v208
    v_fmac_f32 v10, v8, v128
    v_fmac_f32 v11, v9, v128
    v_lshlrev_b32 v8, 16, v209
    v_and_b32 v9, 0xffff0000, v209
    v_fmac_f32 v12, v8, v128
    v_fmac_f32 v13, v9, v128
    v_lshlrev_b32 v8, 16, v210
    v_and_b32 v9, 0xffff0000, v210
    v_fmac_f32 v14, v8, v128
    v_fmac_f32 v15, v9, v128
    s_waitcnt vmcnt(6)
    v_lshlrev_b32 v8, 16, v212
    v_and_b32 v9, 0xffff0000, v212
    v_fmac_f32 v10, v8, v132
    v_fmac_f32 v11, v9, v132
    v_lshlrev_b32 v8, 16, v213
    v_and_b32 v9, 0xffff0000, v213
    v_fmac_f32 v12, v8, v132
    v_fmac_f32 v13, v9, v132
    v_lshlrev_b32 v8, 16, v214
    v_and_b32 v9, 0xffff0000, v214
    v_fmac_f32 v14, v8, v132
    v_fmac_f32 v15, v9, v132
    s_waitcnt vmcnt(5)
    v_lshlrev_b32 v8, 16, v216
    v_and_b32 v9, 0xffff0000, v216
    v_fmac_f32 v10, v8, v136
    v_fmac_f32 v11, v9, v136
    v_lshlrev_b32 v8, 16, v217
    v_and_b32 v9, 0xffff0000, v217
    v_fmac_f32 v12, v8, v136
    v_fmac_f32 v13, v9, v136
    v_lshlrev_b32 v8, 16, v218
    v_and_b32 v9, 0xffff0000, v218
    v_fmac_f32 v14, v8, v136
    v_fmac_f32 v15, v9, v136
    s_waitcnt vmcnt(4)
    v_lshlrev_b32 v8, 16, v220
    v_and_b32 v9, 0xffff0000, v220
    v_fmac_f32 v10, v8, v140
    v_fmac_f32 v11, v9, v140
    v_lshlrev_b32 v8, 16, v221
    v_and_b32 v9, 0xffff0000, v221
    v_fmac_f32 v12, v8, v140
    v_fmac_f32 v13, v9, v140
    v_lshlrev_b32 v8, 16, v222
    v_and_b32 v9, 0xffff0000, v222
    v_fmac_f32 v14, v8, v140
    v_fmac_f32 v15, v9, v140
    s_waitcnt vmcnt(3)
    v_lshlrev_b32 v8, 16, v224
    v_and_b32 v9, 0xffff0000, v224
    v_fmac_f32 v10, v8, v144
    v_fmac_f32 v11, v9, v144
    v_lshlrev_b32 v8, 16, v225
    v_and_b32 v9, 0xffff0000, v225
    v_fmac_f32 v12, v8, v144
    v_fmac_f32 v13, v9, v144
    v_lshlrev_b32 v8, 16, v226
    v_and_b32 v9, 0xffff0000, v226
    v_fmac_f32 v14, v8, v144
    v_fmac_f32 v15, v9, v144
    s_waitcnt vmcnt(2)
    v_lshlrev_b32 v8, 16, v228
    v_and_b32 v9, 0xffff0000, v228
    v_fmac_f32 v10, v8, v148
    v_fmac_f32 v11, v9, v148
    v_lshlrev_b32 v8, 16, v229
    v_and_b32 v9, 0xffff0000, v229
    v_fmac_f32 v12, v8, v148
    v_fmac_f32 v13, v9, v148
    v_lshlrev_b32 v8, 16, v230
    v_and_b32 v9, 0xffff0000, v230
    v_fmac_f32 v14, v8, v148
    v_fmac_f32 v15, v9, v148
    s_waitcnt vmcnt(1)
    v_lshlrev_b32 v8, 16, v232
    v_and_b32 v9, 0xffff0000, v232
    v_fmac_f32 v10, v8, v152
    v_fmac_f32 v11, v9, v152
    v_lshlrev_b32 v8, 16, v233
    v_and_b32 v9, 0xffff0000, v233
    v_fmac_f32 v12, v8, v152
    v_fmac_f32 v13, v9, v152
    v_lshlrev_b32 v8, 16, v234
    v_and_b32 v9, 0xffff0000, v234
    v_fmac_f32 v14, v8, v152
    v_fmac_f32 v15, v9, v152
    s_waitcnt vmcnt(0)
    v_lshlrev_b32 v8, 16, v236
    v_and_b32 v9, 0xffff0000, v236
    v_fmac_f32 v10, v8, v156
    v_fmac_f32 v11, v9, v156
    v_lshlrev_b32 v8, 16, v237
    v_and_b32 v9, 0xffff0000, v237
    v_fmac_f32 v12, v8, v156
    v_fmac_f32 v13, v9, v156
    v_lshlrev_b32 v8, 16, v238
    v_and_b32 v9, 0xffff0000, v238
    v_fmac_f32 v14, v8, v156
    v_fmac_f32 v15, v9, v156
    v_lshlrev_b32 v140, 1, v1
    v_add_u32 v140, v140, v3
    v_mul_u32_u24 v140, 768, v140
    v_lshlrev_b32 v141, 1, v5
    v_add_u32 v140, v140, v141
    ds_write_b64 v140, v[10:11] offset:4096
    ds_write_b64 v140, v[12:13] offset:4104
    ds_write_b64 v140, v[14:15] offset:4112
    s_waitcnt lgkmcnt(0)
    s_barrier
    v_lshlrev_b32 v140, 2, v0
    v_cmp_gt_u32 vcc, 192, v0
    s_and_saveexec_b64 s[28:29], vcc

    ds_read_b32 v144, v140 offset:4096
    ds_read_b32 v145, v140 offset:4864
    ds_read_b32 v146, v140 offset:5632
    ds_read_b32 v147, v140 offset:6400
    ds_read_b32 v148, v140 offset:7168
    ds_read_b32 v149, v140 offset:7936
    ds_read_b32 v150, v140 offset:8704
    ds_read_b32 v151, v140 offset:9472
    s_waitcnt lgkmcnt(0)
    v_add_f32 v144, v144, v145
    v_add_f32 v144, v144, v146
    v_add_f32 v144, v144, v147
    v_add_f32 v144, v144, v148
    v_add_f32 v144, v144, v149
    v_add_f32 v144, v144, v150
    v_add_f32 v144, v144, v151
    s_lshl_b32 s24, s7, 5
    s_add_u32 s24, s24, s6
    s_mul_i32 s24, s24, 768
    s_add_u32 s24, s24, 851968
    buffer_store_dword v144, v140, s[8:11], s24 offen

comb_exit:
    s_endpgm
.p2align 8
.type projb_kernel,@function
projb_kernel:
    s_cmp_ge_u32 s2, 128
    s_cbranch_scc1 projb_exit
    s_load_dwordx2 s[4:5], s[0:1], 104
    s_load_dwordx2 s[12:13], s[0:1], 80
    v_lshrrev_b32 v1, 6, v0
    s_nop 0
    v_readfirstlane_b32 s3, v1
    v_and_b32 v2, 63, v0
    s_and_b32 s6, s2, 31
    s_lshr_b32 s7, s2, 5
    s_waitcnt lgkmcnt(0)

    s_mov_b32 s8, s4
    s_and_b32 s9, s5, 0xffff
    s_mov_b32 s10, 8388608
    s_mov_b32 s11, 0x00020000

    s_mov_b32 s16, s12
    s_and_b32 s17, s13, 0xffff
    s_mov_b32 s18, 7864320
    s_mov_b32 s19, 0x00020000

    s_mul_i32 s24, s6, 768
    s_mul_i32 s25, s7, 192
    s_add_u32 s24, s24, s25
    s_add_u32 s24, s24, 851968
    v_lshlrev_b32 v6, 2, v0

    buffer_load_dword v192, v6, s[8:11], s24 offen
    s_add_u32 s24, s24, 24576
    buffer_load_dword v193, v6, s[8:11], s24 offen
    s_add_u32 s24, s24, 24576
    buffer_load_dword v194, v6, s[8:11], s24 offen
    s_add_u32 s24, s24, 24576
    buffer_load_dword v195, v6, s[8:11], s24 offen
    s_add_u32 s24, s24, 24576
    buffer_load_dword v196, v6, s[8:11], s24 offen
    s_add_u32 s24, s24, 24576
    buffer_load_dword v197, v6, s[8:11], s24 offen
    s_add_u32 s24, s24, 24576
    buffer_load_dword v198, v6, s[8:11], s24 offen
    s_add_u32 s24, s24, 24576
    buffer_load_dword v199, v6, s[8:11], s24 offen
    s_add_u32 s24, s24, 24576
    s_mul_i32 s31, s6, 192
    s_mul_i32 s25, s7, 48
    s_add_u32 s31, s31, s25
    s_mul_i32 s25, s3, 12
    s_add_u32 s31, s31, s25
    s_mul_i32 s31, s31, 1280

    v_mul_u32_u24 v252, 20, v2
    buffer_load_dwordx4 v[16:19], v252, s[16:19], s31 offen
    buffer_load_dword v20, v252, s[16:19], s31 offen offset:16
    s_add_u32 s31, s31, 1280
    buffer_load_dwordx4 v[22:25], v252, s[16:19], s31 offen
    buffer_load_dword v26, v252, s[16:19], s31 offen offset:16
    s_add_u32 s31, s31, 1280
    buffer_load_dwordx4 v[28:31], v252, s[16:19], s31 offen
    buffer_load_dword v32, v252, s[16:19], s31 offen offset:16
    s_add_u32 s31, s31, 1280
    buffer_load_dwordx4 v[34:37], v252, s[16:19], s31 offen
    buffer_load_dword v38, v252, s[16:19], s31 offen offset:16
    s_add_u32 s31, s31, 1280
    buffer_load_dwordx4 v[40:43], v252, s[16:19], s31 offen
    buffer_load_dword v44, v252, s[16:19], s31 offen offset:16
    s_add_u32 s31, s31, 1280
    buffer_load_dwordx4 v[46:49], v252, s[16:19], s31 offen
    buffer_load_dword v50, v252, s[16:19], s31 offen offset:16
    s_add_u32 s31, s31, 1280
    buffer_load_dwordx4 v[52:55], v252, s[16:19], s31 offen
    buffer_load_dword v56, v252, s[16:19], s31 offen offset:16
    s_add_u32 s31, s31, 1280
    buffer_load_dwordx4 v[58:61], v252, s[16:19], s31 offen
    buffer_load_dword v62, v252, s[16:19], s31 offen offset:16
    s_add_u32 s31, s31, 1280
    buffer_load_dwordx4 v[64:67], v252, s[16:19], s31 offen
    buffer_load_dword v68, v252, s[16:19], s31 offen offset:16
    s_add_u32 s31, s31, 1280
    buffer_load_dwordx4 v[70:73], v252, s[16:19], s31 offen
    buffer_load_dword v74, v252, s[16:19], s31 offen offset:16
    s_add_u32 s31, s31, 1280
    buffer_load_dwordx4 v[76:79], v252, s[16:19], s31 offen
    buffer_load_dword v80, v252, s[16:19], s31 offen offset:16
    s_add_u32 s31, s31, 1280
    buffer_load_dwordx4 v[82:85], v252, s[16:19], s31 offen
    buffer_load_dword v86, v252, s[16:19], s31 offen offset:16
    s_add_u32 s31, s31, 1280
    s_waitcnt vmcnt(24)
    v_add_f32 v192, v192, v193
    v_add_f32 v192, v192, v194
    v_add_f32 v192, v192, v195
    v_add_f32 v192, v192, v196
    v_add_f32 v192, v192, v197
    v_add_f32 v192, v192, v198
    v_add_f32 v192, v192, v199
    v_cvt_pk_bf16_f32 v10, v192, v192
    v_lshlrev_b32 v10, 16, v10
    v_cmp_gt_u32 vcc, 48, v0
    s_and_saveexec_b64 s[28:29], vcc
    ds_write_b32 v6, v10
    s_mov_b64 exec, -1
    s_waitcnt lgkmcnt(0)
    s_barrier
    v_mul_u32_u24 v253, 48, v1
    s_add_u32 s2, s2, 128

    ds_read_b32 v160, v253 offset:0
    ds_read_b32 v161, v253 offset:4
    ds_read_b32 v162, v253 offset:8
    ds_read_b32 v163, v253 offset:12
    ds_read_b32 v164, v253 offset:16
    ds_read_b32 v165, v253 offset:20
    ds_read_b32 v166, v253 offset:24
    ds_read_b32 v167, v253 offset:28
    ds_read_b32 v168, v253 offset:32
    ds_read_b32 v169, v253 offset:36
    ds_read_b32 v170, v253 offset:40
    ds_read_b32 v171, v253 offset:44
    v_mov_b32 v240, 0
    v_mov_b32 v241, 0
    v_mov_b32 v242, 0
    v_mov_b32 v243, 0
    v_mov_b32 v244, 0
    v_mov_b32 v245, 0
    v_mov_b32 v246, 0
    v_mov_b32 v247, 0
    v_mov_b32 v248, 0
    v_mov_b32 v249, 0
    s_waitcnt lgkmcnt(0)
    s_waitcnt vmcnt(22)
    v_lshlrev_b32 v6, 16, v16
    v_and_b32 v7, 0xffff0000, v16
    v_fmac_f32 v240, v6, v160
    v_fmac_f32 v241, v7, v160
    v_lshlrev_b32 v6, 16, v17
    v_and_b32 v7, 0xffff0000, v17
    v_fmac_f32 v242, v6, v160
    v_fmac_f32 v243, v7, v160
    v_lshlrev_b32 v6, 16, v18
    v_and_b32 v7, 0xffff0000, v18
    v_fmac_f32 v244, v6, v160
    v_fmac_f32 v245, v7, v160
    v_lshlrev_b32 v6, 16, v19
    v_and_b32 v7, 0xffff0000, v19
    v_fmac_f32 v246, v6, v160
    v_fmac_f32 v247, v7, v160
    v_lshlrev_b32 v6, 16, v20
    v_and_b32 v7, 0xffff0000, v20
    v_fmac_f32 v248, v6, v160
    v_fmac_f32 v249, v7, v160
    s_waitcnt vmcnt(20)
    v_lshlrev_b32 v6, 16, v22
    v_and_b32 v7, 0xffff0000, v22
    v_fmac_f32 v240, v6, v161
    v_fmac_f32 v241, v7, v161
    v_lshlrev_b32 v6, 16, v23
    v_and_b32 v7, 0xffff0000, v23
    v_fmac_f32 v242, v6, v161
    v_fmac_f32 v243, v7, v161
    v_lshlrev_b32 v6, 16, v24
    v_and_b32 v7, 0xffff0000, v24
    v_fmac_f32 v244, v6, v161
    v_fmac_f32 v245, v7, v161
    v_lshlrev_b32 v6, 16, v25
    v_and_b32 v7, 0xffff0000, v25
    v_fmac_f32 v246, v6, v161
    v_fmac_f32 v247, v7, v161
    v_lshlrev_b32 v6, 16, v26
    v_and_b32 v7, 0xffff0000, v26
    v_fmac_f32 v248, v6, v161
    v_fmac_f32 v249, v7, v161
    s_waitcnt vmcnt(18)
    v_lshlrev_b32 v6, 16, v28
    v_and_b32 v7, 0xffff0000, v28
    v_fmac_f32 v240, v6, v162
    v_fmac_f32 v241, v7, v162
    v_lshlrev_b32 v6, 16, v29
    v_and_b32 v7, 0xffff0000, v29
    v_fmac_f32 v242, v6, v162
    v_fmac_f32 v243, v7, v162
    v_lshlrev_b32 v6, 16, v30
    v_and_b32 v7, 0xffff0000, v30
    v_fmac_f32 v244, v6, v162
    v_fmac_f32 v245, v7, v162
    v_lshlrev_b32 v6, 16, v31
    v_and_b32 v7, 0xffff0000, v31
    v_fmac_f32 v246, v6, v162
    v_fmac_f32 v247, v7, v162
    v_lshlrev_b32 v6, 16, v32
    v_and_b32 v7, 0xffff0000, v32
    v_fmac_f32 v248, v6, v162
    v_fmac_f32 v249, v7, v162
    s_waitcnt vmcnt(16)
    v_lshlrev_b32 v6, 16, v34
    v_and_b32 v7, 0xffff0000, v34
    v_fmac_f32 v240, v6, v163
    v_fmac_f32 v241, v7, v163
    v_lshlrev_b32 v6, 16, v35
    v_and_b32 v7, 0xffff0000, v35
    v_fmac_f32 v242, v6, v163
    v_fmac_f32 v243, v7, v163
    v_lshlrev_b32 v6, 16, v36
    v_and_b32 v7, 0xffff0000, v36
    v_fmac_f32 v244, v6, v163
    v_fmac_f32 v245, v7, v163
    v_lshlrev_b32 v6, 16, v37
    v_and_b32 v7, 0xffff0000, v37
    v_fmac_f32 v246, v6, v163
    v_fmac_f32 v247, v7, v163
    v_lshlrev_b32 v6, 16, v38
    v_and_b32 v7, 0xffff0000, v38
    v_fmac_f32 v248, v6, v163
    v_fmac_f32 v249, v7, v163
    s_waitcnt vmcnt(14)
    v_lshlrev_b32 v6, 16, v40
    v_and_b32 v7, 0xffff0000, v40
    v_fmac_f32 v240, v6, v164
    v_fmac_f32 v241, v7, v164
    v_lshlrev_b32 v6, 16, v41
    v_and_b32 v7, 0xffff0000, v41
    v_fmac_f32 v242, v6, v164
    v_fmac_f32 v243, v7, v164
    v_lshlrev_b32 v6, 16, v42
    v_and_b32 v7, 0xffff0000, v42
    v_fmac_f32 v244, v6, v164
    v_fmac_f32 v245, v7, v164
    v_lshlrev_b32 v6, 16, v43
    v_and_b32 v7, 0xffff0000, v43
    v_fmac_f32 v246, v6, v164
    v_fmac_f32 v247, v7, v164
    v_lshlrev_b32 v6, 16, v44
    v_and_b32 v7, 0xffff0000, v44
    v_fmac_f32 v248, v6, v164
    v_fmac_f32 v249, v7, v164
    s_waitcnt vmcnt(12)
    v_lshlrev_b32 v6, 16, v46
    v_and_b32 v7, 0xffff0000, v46
    v_fmac_f32 v240, v6, v165
    v_fmac_f32 v241, v7, v165
    v_lshlrev_b32 v6, 16, v47
    v_and_b32 v7, 0xffff0000, v47
    v_fmac_f32 v242, v6, v165
    v_fmac_f32 v243, v7, v165
    v_lshlrev_b32 v6, 16, v48
    v_and_b32 v7, 0xffff0000, v48
    v_fmac_f32 v244, v6, v165
    v_fmac_f32 v245, v7, v165
    v_lshlrev_b32 v6, 16, v49
    v_and_b32 v7, 0xffff0000, v49
    v_fmac_f32 v246, v6, v165
    v_fmac_f32 v247, v7, v165
    v_lshlrev_b32 v6, 16, v50
    v_and_b32 v7, 0xffff0000, v50
    v_fmac_f32 v248, v6, v165
    v_fmac_f32 v249, v7, v165
    s_waitcnt vmcnt(10)
    v_lshlrev_b32 v6, 16, v52
    v_and_b32 v7, 0xffff0000, v52
    v_fmac_f32 v240, v6, v166
    v_fmac_f32 v241, v7, v166
    v_lshlrev_b32 v6, 16, v53
    v_and_b32 v7, 0xffff0000, v53
    v_fmac_f32 v242, v6, v166
    v_fmac_f32 v243, v7, v166
    v_lshlrev_b32 v6, 16, v54
    v_and_b32 v7, 0xffff0000, v54
    v_fmac_f32 v244, v6, v166
    v_fmac_f32 v245, v7, v166
    v_lshlrev_b32 v6, 16, v55
    v_and_b32 v7, 0xffff0000, v55
    v_fmac_f32 v246, v6, v166
    v_fmac_f32 v247, v7, v166
    v_lshlrev_b32 v6, 16, v56
    v_and_b32 v7, 0xffff0000, v56
    v_fmac_f32 v248, v6, v166
    v_fmac_f32 v249, v7, v166
    s_waitcnt vmcnt(8)
    v_lshlrev_b32 v6, 16, v58
    v_and_b32 v7, 0xffff0000, v58
    v_fmac_f32 v240, v6, v167
    v_fmac_f32 v241, v7, v167
    v_lshlrev_b32 v6, 16, v59
    v_and_b32 v7, 0xffff0000, v59
    v_fmac_f32 v242, v6, v167
    v_fmac_f32 v243, v7, v167
    v_lshlrev_b32 v6, 16, v60
    v_and_b32 v7, 0xffff0000, v60
    v_fmac_f32 v244, v6, v167
    v_fmac_f32 v245, v7, v167
    v_lshlrev_b32 v6, 16, v61
    v_and_b32 v7, 0xffff0000, v61
    v_fmac_f32 v246, v6, v167
    v_fmac_f32 v247, v7, v167
    v_lshlrev_b32 v6, 16, v62
    v_and_b32 v7, 0xffff0000, v62
    v_fmac_f32 v248, v6, v167
    v_fmac_f32 v249, v7, v167
    s_waitcnt vmcnt(6)
    v_lshlrev_b32 v6, 16, v64
    v_and_b32 v7, 0xffff0000, v64
    v_fmac_f32 v240, v6, v168
    v_fmac_f32 v241, v7, v168
    v_lshlrev_b32 v6, 16, v65
    v_and_b32 v7, 0xffff0000, v65
    v_fmac_f32 v242, v6, v168
    v_fmac_f32 v243, v7, v168
    v_lshlrev_b32 v6, 16, v66
    v_and_b32 v7, 0xffff0000, v66
    v_fmac_f32 v244, v6, v168
    v_fmac_f32 v245, v7, v168
    v_lshlrev_b32 v6, 16, v67
    v_and_b32 v7, 0xffff0000, v67
    v_fmac_f32 v246, v6, v168
    v_fmac_f32 v247, v7, v168
    v_lshlrev_b32 v6, 16, v68
    v_and_b32 v7, 0xffff0000, v68
    v_fmac_f32 v248, v6, v168
    v_fmac_f32 v249, v7, v168
    s_waitcnt vmcnt(4)
    v_lshlrev_b32 v6, 16, v70
    v_and_b32 v7, 0xffff0000, v70
    v_fmac_f32 v240, v6, v169
    v_fmac_f32 v241, v7, v169
    v_lshlrev_b32 v6, 16, v71
    v_and_b32 v7, 0xffff0000, v71
    v_fmac_f32 v242, v6, v169
    v_fmac_f32 v243, v7, v169
    v_lshlrev_b32 v6, 16, v72
    v_and_b32 v7, 0xffff0000, v72
    v_fmac_f32 v244, v6, v169
    v_fmac_f32 v245, v7, v169
    v_lshlrev_b32 v6, 16, v73
    v_and_b32 v7, 0xffff0000, v73
    v_fmac_f32 v246, v6, v169
    v_fmac_f32 v247, v7, v169
    v_lshlrev_b32 v6, 16, v74
    v_and_b32 v7, 0xffff0000, v74
    v_fmac_f32 v248, v6, v169
    v_fmac_f32 v249, v7, v169
    s_waitcnt vmcnt(2)
    v_lshlrev_b32 v6, 16, v76
    v_and_b32 v7, 0xffff0000, v76
    v_fmac_f32 v240, v6, v170
    v_fmac_f32 v241, v7, v170
    v_lshlrev_b32 v6, 16, v77
    v_and_b32 v7, 0xffff0000, v77
    v_fmac_f32 v242, v6, v170
    v_fmac_f32 v243, v7, v170
    v_lshlrev_b32 v6, 16, v78
    v_and_b32 v7, 0xffff0000, v78
    v_fmac_f32 v244, v6, v170
    v_fmac_f32 v245, v7, v170
    v_lshlrev_b32 v6, 16, v79
    v_and_b32 v7, 0xffff0000, v79
    v_fmac_f32 v246, v6, v170
    v_fmac_f32 v247, v7, v170
    v_lshlrev_b32 v6, 16, v80
    v_and_b32 v7, 0xffff0000, v80
    v_fmac_f32 v248, v6, v170
    v_fmac_f32 v249, v7, v170
    s_waitcnt vmcnt(0)
    v_lshlrev_b32 v6, 16, v82
    v_and_b32 v7, 0xffff0000, v82
    v_fmac_f32 v240, v6, v171
    v_fmac_f32 v241, v7, v171
    v_lshlrev_b32 v6, 16, v83
    v_and_b32 v7, 0xffff0000, v83
    v_fmac_f32 v242, v6, v171
    v_fmac_f32 v243, v7, v171
    v_lshlrev_b32 v6, 16, v84
    v_and_b32 v7, 0xffff0000, v84
    v_fmac_f32 v244, v6, v171
    v_fmac_f32 v245, v7, v171
    v_lshlrev_b32 v6, 16, v85
    v_and_b32 v7, 0xffff0000, v85
    v_fmac_f32 v246, v6, v171
    v_fmac_f32 v247, v7, v171
    v_lshlrev_b32 v6, 16, v86
    v_and_b32 v7, 0xffff0000, v86
    v_fmac_f32 v248, v6, v171
    v_fmac_f32 v249, v7, v171
    v_mul_u32_u24 v6, 2560, v1
    v_mul_u32_u24 v7, 40, v2
    v_add_u32 v6, v6, v7
    s_barrier
    ds_write_b64 v6, v[240:241] offset:4096
    ds_write_b64 v6, v[242:243] offset:4104
    ds_write_b64 v6, v[244:245] offset:4112
    ds_write_b64 v6, v[246:247] offset:4120
    ds_write_b64 v6, v[248:249] offset:4128
    s_waitcnt lgkmcnt(0)
    s_barrier
    v_cmp_gt_u32 vcc, 160, v0
    s_and_saveexec_b64 s[28:29], vcc
    s_cbranch_execz projb_exit
    v_lshlrev_b32 v6, 4, v0
    ds_read_b128 v[16:19], v6 offset:4096
    ds_read_b128 v[20:23], v6 offset:6656
    ds_read_b128 v[24:27], v6 offset:9216
    ds_read_b128 v[28:31], v6 offset:11776
    s_mul_i32 s24, s2, 2560
    s_add_u32 s24, s24, 7340032
    s_waitcnt lgkmcnt(0)

    v_add_f32 v16, v16, v20
    v_add_f32 v24, v24, v28
    v_add_f32 v16, v16, v24
    v_add_f32 v17, v17, v21
    v_add_f32 v25, v25, v29
    v_add_f32 v17, v17, v25
    v_add_f32 v18, v18, v22
    v_add_f32 v26, v26, v30
    v_add_f32 v18, v18, v26
    v_add_f32 v19, v19, v23
    v_add_f32 v27, v27, v31
    v_add_f32 v19, v19, v27
    buffer_store_dwordx4 v[16:19], v6, s[8:11], s24 offen
    s_branch projb_exit

projb_exit:
    s_endpgm
.p2align 8
.type fin_kernel,@function
fin_kernel:
    s_cmp_ge_u32 s2, 20
    s_cbranch_scc1 fin_exit
    s_load_dwordx2 s[4:5], s[0:1], 104
    s_load_dwordx2 s[6:7], s[0:1], 88
    v_lshrrev_b32 v1, 6, v0
    v_and_b32 v2, 63, v0
    s_waitcnt lgkmcnt(0)

    s_mov_b32 s8, s4
    s_and_b32 s9, s5, 0xffff
    s_mov_b32 s10, 8388608
    s_mov_b32 s11, 0x00020000

    s_mov_b32 s12, s6
    s_and_b32 s13, s7, 0xffff
    s_mov_b32 s14, 2560
    s_mov_b32 s15, 0x00020000

    v_mul_u32_u24 v5, 2560, v1
    v_lshlrev_b32 v6, 2, v2
    v_add_u32 v5, v5, v6
    v_mov_b32 v8, 0
    s_cmp_ge_u32 s2, 10
    s_cbranch_scc1 fin_B
    s_lshl_b32 s16, s2, 8
    s_add_u32 s16, s16, 7340032

    buffer_load_dword v16, v5, s[8:11], s16 offen
    s_add_u32 s16, s16, 10240
    buffer_load_dword v17, v5, s[8:11], s16 offen
    s_add_u32 s16, s16, 10240
    buffer_load_dword v18, v5, s[8:11], s16 offen
    s_add_u32 s16, s16, 10240
    buffer_load_dword v19, v5, s[8:11], s16 offen
    s_add_u32 s16, s16, 10240
    buffer_load_dword v20, v5, s[8:11], s16 offen
    s_add_u32 s16, s16, 10240
    buffer_load_dword v21, v5, s[8:11], s16 offen
    s_add_u32 s16, s16, 10240
    buffer_load_dword v22, v5, s[8:11], s16 offen
    s_add_u32 s16, s16, 10240
    buffer_load_dword v23, v5, s[8:11], s16 offen
    s_add_u32 s16, s16, 10240
    buffer_load_dword v24, v5, s[8:11], s16 offen
    s_add_u32 s16, s16, 10240
    buffer_load_dword v25, v5, s[8:11], s16 offen
    s_add_u32 s16, s16, 10240
    buffer_load_dword v26, v5, s[8:11], s16 offen
    s_add_u32 s16, s16, 10240
    buffer_load_dword v27, v5, s[8:11], s16 offen
    s_add_u32 s16, s16, 10240
    buffer_load_dword v28, v5, s[8:11], s16 offen
    s_add_u32 s16, s16, 10240
    buffer_load_dword v29, v5, s[8:11], s16 offen
    s_add_u32 s16, s16, 10240
    buffer_load_dword v30, v5, s[8:11], s16 offen
    s_add_u32 s16, s16, 10240
    buffer_load_dword v31, v5, s[8:11], s16 offen
    s_add_u32 s16, s16, 10240
    buffer_load_dword v32, v5, s[8:11], s16 offen
    s_add_u32 s16, s16, 10240
    buffer_load_dword v33, v5, s[8:11], s16 offen
    s_add_u32 s16, s16, 10240
    buffer_load_dword v34, v5, s[8:11], s16 offen
    s_add_u32 s16, s16, 10240
    buffer_load_dword v35, v5, s[8:11], s16 offen
    s_add_u32 s16, s16, 10240
    buffer_load_dword v36, v5, s[8:11], s16 offen
    s_add_u32 s16, s16, 10240
    buffer_load_dword v37, v5, s[8:11], s16 offen
    s_add_u32 s16, s16, 10240
    buffer_load_dword v38, v5, s[8:11], s16 offen
    s_add_u32 s16, s16, 10240
    buffer_load_dword v39, v5, s[8:11], s16 offen
    s_add_u32 s16, s16, 10240
    buffer_load_dword v40, v5, s[8:11], s16 offen
    s_add_u32 s16, s16, 10240
    buffer_load_dword v41, v5, s[8:11], s16 offen
    s_add_u32 s16, s16, 10240
    buffer_load_dword v42, v5, s[8:11], s16 offen
    s_add_u32 s16, s16, 10240
    buffer_load_dword v43, v5, s[8:11], s16 offen
    s_add_u32 s16, s16, 10240
    buffer_load_dword v44, v5, s[8:11], s16 offen
    s_add_u32 s16, s16, 10240
    buffer_load_dword v45, v5, s[8:11], s16 offen
    s_add_u32 s16, s16, 10240
    buffer_load_dword v46, v5, s[8:11], s16 offen
    s_add_u32 s16, s16, 10240
    buffer_load_dword v47, v5, s[8:11], s16 offen
    s_add_u32 s16, s16, 10240
    s_waitcnt vmcnt(0)
    v_add_f32 v8, v8, v16
    v_add_f32 v8, v8, v17
    v_add_f32 v8, v8, v18
    v_add_f32 v8, v8, v19
    v_add_f32 v8, v8, v20
    v_add_f32 v8, v8, v21
    v_add_f32 v8, v8, v22
    v_add_f32 v8, v8, v23
    v_add_f32 v8, v8, v24
    v_add_f32 v8, v8, v25
    v_add_f32 v8, v8, v26
    v_add_f32 v8, v8, v27
    v_add_f32 v8, v8, v28
    v_add_f32 v8, v8, v29
    v_add_f32 v8, v8, v30
    v_add_f32 v8, v8, v31
    v_add_f32 v8, v8, v32
    v_add_f32 v8, v8, v33
    v_add_f32 v8, v8, v34
    v_add_f32 v8, v8, v35
    v_add_f32 v8, v8, v36
    v_add_f32 v8, v8, v37
    v_add_f32 v8, v8, v38
    v_add_f32 v8, v8, v39
    v_add_f32 v8, v8, v40
    v_add_f32 v8, v8, v41
    v_add_f32 v8, v8, v42
    v_add_f32 v8, v8, v43
    v_add_f32 v8, v8, v44
    v_add_f32 v8, v8, v45
    v_add_f32 v8, v8, v46
    v_add_f32 v8, v8, v47
    s_branch fin_J
fin_B:
    s_sub_u32 s16, s2, 10
    s_lshl_b32 s16, s16, 8
    s_add_u32 s16, s16, 7667712

    buffer_load_dword v16, v5, s[8:11], s16 offen
    s_add_u32 s16, s16, 10240
    buffer_load_dword v17, v5, s[8:11], s16 offen
    s_add_u32 s16, s16, 10240
    buffer_load_dword v18, v5, s[8:11], s16 offen
    s_add_u32 s16, s16, 10240
    buffer_load_dword v19, v5, s[8:11], s16 offen
    s_add_u32 s16, s16, 10240
    buffer_load_dword v20, v5, s[8:11], s16 offen
    s_add_u32 s16, s16, 10240
    buffer_load_dword v21, v5, s[8:11], s16 offen
    s_add_u32 s16, s16, 10240
    buffer_load_dword v22, v5, s[8:11], s16 offen
    s_add_u32 s16, s16, 10240
    buffer_load_dword v23, v5, s[8:11], s16 offen
    s_add_u32 s16, s16, 10240
    buffer_load_dword v24, v5, s[8:11], s16 offen
    s_add_u32 s16, s16, 10240
    buffer_load_dword v25, v5, s[8:11], s16 offen
    s_add_u32 s16, s16, 10240
    buffer_load_dword v26, v5, s[8:11], s16 offen
    s_add_u32 s16, s16, 10240
    buffer_load_dword v27, v5, s[8:11], s16 offen
    s_add_u32 s16, s16, 10240
    buffer_load_dword v28, v5, s[8:11], s16 offen
    s_add_u32 s16, s16, 10240
    buffer_load_dword v29, v5, s[8:11], s16 offen
    s_add_u32 s16, s16, 10240
    buffer_load_dword v30, v5, s[8:11], s16 offen
    s_add_u32 s16, s16, 10240
    buffer_load_dword v31, v5, s[8:11], s16 offen
    s_add_u32 s16, s16, 10240
    buffer_load_dword v32, v5, s[8:11], s16 offen
    s_add_u32 s16, s16, 10240
    buffer_load_dword v33, v5, s[8:11], s16 offen
    s_add_u32 s16, s16, 10240
    buffer_load_dword v34, v5, s[8:11], s16 offen
    s_add_u32 s16, s16, 10240
    buffer_load_dword v35, v5, s[8:11], s16 offen
    s_add_u32 s16, s16, 10240
    buffer_load_dword v36, v5, s[8:11], s16 offen
    s_add_u32 s16, s16, 10240
    buffer_load_dword v37, v5, s[8:11], s16 offen
    s_add_u32 s16, s16, 10240
    buffer_load_dword v38, v5, s[8:11], s16 offen
    s_add_u32 s16, s16, 10240
    buffer_load_dword v39, v5, s[8:11], s16 offen
    s_add_u32 s16, s16, 10240
    buffer_load_dword v40, v5, s[8:11], s16 offen
    s_add_u32 s16, s16, 10240
    buffer_load_dword v41, v5, s[8:11], s16 offen
    s_add_u32 s16, s16, 10240
    buffer_load_dword v42, v5, s[8:11], s16 offen
    s_add_u32 s16, s16, 10240
    buffer_load_dword v43, v5, s[8:11], s16 offen
    s_add_u32 s16, s16, 10240
    buffer_load_dword v44, v5, s[8:11], s16 offen
    s_add_u32 s16, s16, 10240
    buffer_load_dword v45, v5, s[8:11], s16 offen
    s_add_u32 s16, s16, 10240
    buffer_load_dword v46, v5, s[8:11], s16 offen
    s_add_u32 s16, s16, 10240
    buffer_load_dword v47, v5, s[8:11], s16 offen
    s_add_u32 s16, s16, 10240
    s_waitcnt vmcnt(0)
    v_add_f32 v8, v8, v16
    v_add_f32 v8, v8, v17
    v_add_f32 v8, v8, v18
    v_add_f32 v8, v8, v19
    v_add_f32 v8, v8, v20
    v_add_f32 v8, v8, v21
    v_add_f32 v8, v8, v22
    v_add_f32 v8, v8, v23
    v_add_f32 v8, v8, v24
    v_add_f32 v8, v8, v25
    v_add_f32 v8, v8, v26
    v_add_f32 v8, v8, v27
    v_add_f32 v8, v8, v28
    v_add_f32 v8, v8, v29
    v_add_f32 v8, v8, v30
    v_add_f32 v8, v8, v31
    v_add_f32 v8, v8, v32
    v_add_f32 v8, v8, v33
    v_add_f32 v8, v8, v34
    v_add_f32 v8, v8, v35
    v_add_f32 v8, v8, v36
    v_add_f32 v8, v8, v37
    v_add_f32 v8, v8, v38
    v_add_f32 v8, v8, v39
    v_add_f32 v8, v8, v40
    v_add_f32 v8, v8, v41
    v_add_f32 v8, v8, v42
    v_add_f32 v8, v8, v43
    v_add_f32 v8, v8, v44
    v_add_f32 v8, v8, v45
    v_add_f32 v8, v8, v46
    v_add_f32 v8, v8, v47
fin_J:
    v_lshlrev_b32 v6, 2, v0
    ds_write_b32 v6, v8
    s_waitcnt lgkmcnt(0)
    s_barrier
    v_cmp_gt_u32 vcc, 64, v0
    s_and_saveexec_b64 s[28:29], vcc
    s_cbranch_execz fin_exit
    ds_read_b32 v8, v6
    ds_read_b32 v9, v6 offset:256
    ds_read_b32 v10, v6 offset:512
    ds_read_b32 v11, v6 offset:768
    s_waitcnt lgkmcnt(0)
    v_add_f32 v8, v8, v9
    v_add_f32 v10, v10, v11
    v_add_f32 v8, v8, v10
    v_cvt_pk_bf16_f32 v8, v8, v8
    v_lshlrev_b32 v6, 1, v0
    s_lshl_b32 s16, s2, 7
    buffer_store_short v8, v6, s[12:15], s16 offen

fin_exit:
    s_endpgm
.section .rodata,"a"
.p2align 6
.amdhsa_kernel prep_kernel
  .amdhsa_next_free_vgpr 192
  .amdhsa_next_free_sgpr 102
  .amdhsa_accum_offset 192
  .amdhsa_group_segment_fixed_size 0
  .amdhsa_kernarg_size 112
  .amdhsa_user_sgpr_count 2
  .amdhsa_user_sgpr_kernarg_segment_ptr 1
  .amdhsa_system_sgpr_workgroup_id_x 1
.end_amdhsa_kernel
.p2align 6
.amdhsa_kernel attn_kernel
  .amdhsa_next_free_vgpr 208
  .amdhsa_next_free_sgpr 102
  .amdhsa_accum_offset 208
  .amdhsa_group_segment_fixed_size 0
  .amdhsa_kernarg_size 112
  .amdhsa_user_sgpr_count 2
  .amdhsa_user_sgpr_kernarg_segment_ptr 1
  .amdhsa_system_sgpr_workgroup_id_x 1
.end_amdhsa_kernel
.p2align 6
.amdhsa_kernel comb_kernel
  .amdhsa_next_free_vgpr 256
  .amdhsa_next_free_sgpr 102
  .amdhsa_accum_offset 256
  .amdhsa_group_segment_fixed_size 0
  .amdhsa_kernarg_size 112
  .amdhsa_user_sgpr_count 2
  .amdhsa_user_sgpr_kernarg_segment_ptr 1
  .amdhsa_system_sgpr_workgroup_id_x 1
.end_amdhsa_kernel
.p2align 6
.amdhsa_kernel projb_kernel
  .amdhsa_next_free_vgpr 256
  .amdhsa_next_free_sgpr 102
  .amdhsa_accum_offset 256
  .amdhsa_group_segment_fixed_size 0
  .amdhsa_kernarg_size 112
  .amdhsa_user_sgpr_count 2
  .amdhsa_user_sgpr_kernarg_segment_ptr 1
  .amdhsa_system_sgpr_workgroup_id_x 1
.end_amdhsa_kernel
.p2align 6
.amdhsa_kernel fin_kernel
  .amdhsa_next_free_vgpr 96
  .amdhsa_next_free_sgpr 102
  .amdhsa_accum_offset 96
  .amdhsa_group_segment_fixed_size 0
  .amdhsa_kernarg_size 112
  .amdhsa_user_sgpr_count 2
  .amdhsa_user_sgpr_kernarg_segment_ptr 1
  .amdhsa_system_sgpr_workgroup_id_x 1
.end_amdhsa_kernel
```
